```python
import torch

def _softmax(x, axis=-1):
    return torch.softmax(x, dim=axis)
def _gelu(x):
    return torch.nn.functional.gelu(x, approximate="tanh")
def _silu(x):
    return torch.nn.functional.silu(x)
def _sigmoid(x):
    return torch.sigmoid(x)
def _layernorm(x, axis=-1, eps=1e-5):
    m = x.mean(dim=axis, keepdim=True)
    v = x.var(dim=axis, keepdim=True, unbiased=False)
    return (x - m) / torch.sqrt(v + eps)
def _scatter_add(tgt, idx, src, axis=0):
    return tgt.clone().index_add_(axis, idx, src)
def _segment_sum(src, seg, n):
    out = torch.zeros((n,) + src.shape[1:], dtype=src.dtype)
    return out.index_add_(0, seg, src)
def _pad(x, pw):
    flat = tuple(v for pair in reversed(pw) for v in pair)
    return torch.nn.functional.pad(x, flat)

kernel_name = 'sequential_preLN__gqa_block_cached__swiglu_ffn__decode'

def setup_inputs():

    _w = (lambda a: (lambda t: t.to(torch.bfloat16) if t.is_floating_point() else t)(torch.as_tensor(a)))
    def _A_setup():
        B, Sq, D = 4, 1, 512
        Hq, Hkv, Sk, Dh = 32, 8, 16384, 128
        assert Hq % Hkv == 0, (Hq, Hkv)
        return {
            "x": _w((lambda *s: torch.randn(*s, dtype=torch.bfloat16) * 0.05)(B, Sq, D)),
            "k_cache": _w((lambda *s: torch.randn(*s, dtype=torch.bfloat16) * 3.2)(B, Hkv, Sk, Dh)),
            "v_cache": _w((lambda *s: torch.randn(*s, dtype=torch.bfloat16) * 0.4)(B, Hkv, Sk, Dh)),
            "wq": _w((lambda *s: torch.randn(*s, dtype=torch.bfloat16) * 3.2)(D, Hq * Dh) * (D ** -0.5)),
            "wo": _w((lambda *s: torch.randn(*s, dtype=torch.bfloat16) * 0.4)(Hq * Dh, D) * ((Hq * Dh) ** -0.5)),
        }
    _A_in = _A_setup()

    def _B_setup():
        B, S, D, F = 4, 1, 512, 1792
        return {
            "x": _w((lambda *s: torch.randn(*s, dtype=torch.bfloat16) * 0.05)(B, S, D)),
            "w_gate": _w((lambda *s: torch.randn(*s, dtype=torch.bfloat16) * 0.05)(D, F)),
            "w_up": _w((lambda *s: torch.randn(*s, dtype=torch.bfloat16) * 0.05)(D, F)),
            "w_down": _w((lambda *s: torch.randn(*s, dtype=torch.bfloat16) * 0.05)(F, D)),
        }
    _B_in = _B_setup()

    return {
        "A_x": _A_in["x"],
        "A_k_cache": _A_in["k_cache"],
        "A_v_cache": _A_in["v_cache"],
        "A_wq": _A_in["wq"],
        "A_wo": _A_in["wo"],
        "B_x": _B_in["x"],
        "B_w_gate": _B_in["w_gate"],
        "B_w_up": _B_in["w_up"],
        "B_w_down": _B_in["w_down"],
    }

def reference(A_x, A_k_cache, A_v_cache, A_wq, A_wo, B_x, B_w_gate, B_w_up, B_w_down):
    def _A_ref(x, k_cache, v_cache, wq, wo):
        B, Sq, D = x.shape
        Hq, Dh = 32, 128
        Hkv = k_cache.shape[1]
        rep = Hq // Hkv
        q = (lambda x, *d: x.permute(*d))((x @ wq).reshape(B, Sq, Hq, Dh), 0, 2, 1, 3)
        k = (lambda x, n, axis: torch.repeat_interleave(x, n, dim=axis))(k_cache, rep, axis=1)
        v = (lambda x, n, axis: torch.repeat_interleave(x, n, dim=axis))(v_cache, rep, axis=1)
        scores = torch.einsum("bhqd,bhkd->bhqk", q, k) * (Dh ** -0.5)
        p = _softmax(scores, axis=-1)
        o = torch.einsum("bhqk,bhkd->bhqd", p, v)
        return (lambda x, *d: x.permute(*d))(o, 0, 2, 1, 3).reshape(B, Sq, Hq * Dh) @ wo

    def _B_ref(x, w_gate, w_up, w_down):
        g = _silu(x @ w_gate)
        u = x @ w_up
        return (g * u) @ w_down

    x = A_x
    h = x + _A_ref(_layernorm(x, axis=-1), A_k_cache, A_v_cache, A_wq, A_wo)
    h2 = h + _B_ref(_layernorm(h, axis=-1), B_w_gate, B_w_up, B_w_down)
    return h2
```

```asm
; @launch grid=(256,1,1) block=(512,1,1) lds=131072
.amdgcn_target "amdgcn-amd-amdhsa--gfx950"
.text
.globl sequential_preLN__gqa_block_cached__swiglu_ffn__decode_kernel
.p2align 8
.type sequential_preLN__gqa_block_cached__swiglu_ffn__decode_kernel,@function
sequential_preLN__gqa_block_cached__swiglu_ffn__decode_kernel:

    s_cmp_ge_u32 s2, 256
    s_cbranch_scc1 L_end
    s_load_dwordx16 s[4:19], s[0:1], 0
    s_load_dwordx8 s[20:27], s[0:1], 64
    v_lshrrev_b32 v1, 6, v0
    v_and_b32 v0, 63, v0
    v_readfirstlane_b32 s28, v1
    s_and_b32 s29, s2, 7
    s_lshr_b32 s32, s2, 3
    s_lshr_b32 s30, s32, 3
    s_and_b32 s31, s32, 7
    s_mov_b32 s98, 0x3db504f3
    s_mov_b32 s99, 0x3db504f3
    s_mov_b32 s53, 0x3fb8aa3b
    s_mov_b32 s54, 0xbfb8aa3b
    s_lshl_b32 s33, s30, 3
    s_add_u32 s33, s33, s29
    s_lshl_b32 s63, s33, 22
    s_lshl_b32 s34, s31, 19
    s_add_u32 s63, s63, s34
    s_lshl_b32 s33, s33, 3
    s_add_u32 s33, s33, s31
    s_mul_i32 s74, s33, 1152
    v_and_b32 v28, 15, v0
    v_lshrrev_b32 v29, 4, v0
    v_lshlrev_b32 v1, 8, v28
    v_lshl_add_u32 v1, v29, 4, v1
    v_lshlrev_b32 v2, 10, v29
    v_lshl_add_u32 v2, v28, 4, v2
    s_lshl_b32 s55, s28, 12
    s_sub_u32 s57, s28, 4
    s_cmp_eq_u32 s28, 5
    s_cbranch_scc1 L_T5
    s_cmp_lg_u32 s28, 4
    s_cbranch_scc1 L_P
    s_setprio 3
    v_lshlrev_b32 v48, 4, v0
    s_lshr_b32 s72, s32, 3
    s_and_b32 s73, s32, 7
    s_lshl_b32 s34, s29, 10
    s_lshl_b32 s35, s73, 7
    s_add_u32 s34, s34, s35
    s_lshl_b32 s35, s72, 20
    s_add_u32 s34, s34, s35
    v_lshrrev_b32 v40, 3, v0
    v_lshlrev_b32 v40, 13, v40
    v_and_b32 v41, 7, v0
    v_lshl_add_u32 v40, v41, 4, v40
    v_lshlrev_b32 v42, 10, v29
    v_lshl_add_u32 v42, v28, 4, v42
    v_mov_b32 v43, v28
    s_mov_b32 s35, 0
    s_waitcnt lgkmcnt(0)
    s_mov_b32 s44, s4
    s_mov_b32 s45, s5
    s_mov_b32 s46, 0x1000
    s_mov_b32 s47, 0x20000
    s_add_u32 s64, s10, s34
    s_addc_u32 s65, s11, 0
    s_mov_b32 s66, 0xfe080
    s_mov_b32 s67, 0x20000
    buffer_load_dwordx4 v[128:131], v42, s[44:47], 0 offen offset:0
    buffer_load_dwordx4 v[132:135], v42, s[44:47], 0 offen offset:256
    buffer_load_dwordx4 v[136:139], v42, s[44:47], 0 offen offset:512
    buffer_load_dwordx4 v[140:143], v42, s[44:47], 0 offen offset:768
    buffer_load_dwordx4 v[192:195], v40, s[64:67], s35 offen
    s_add_u32 s35, s35, 65536
    buffer_load_dwordx4 v[196:199], v40, s[64:67], s35 offen
    s_add_u32 s35, s35, 65536
    buffer_load_dwordx4 v[200:203], v40, s[64:67], s35 offen
    s_add_u32 s35, s35, 65536
    buffer_load_dwordx4 v[204:207], v40, s[64:67], s35 offen
    s_add_u32 s35, s35, 65536
    buffer_load_dwordx4 v[208:211], v40, s[64:67], s35 offen
    s_add_u32 s35, s35, 65536
    buffer_load_dwordx4 v[212:215], v40, s[64:67], s35 offen
    s_add_u32 s35, s35, 65536
    buffer_load_dwordx4 v[216:219], v40, s[64:67], s35 offen
    s_add_u32 s35, s35, 65536
    buffer_load_dwordx4 v[220:223], v40, s[64:67], s35 offen
    s_add_u32 s35, s35, 65536
    buffer_load_dwordx4 v[224:227], v40, s[64:67], s35 offen
    s_add_u32 s35, s35, 65536
    buffer_load_dwordx4 v[228:231], v40, s[64:67], s35 offen
    s_add_u32 s35, s35, 65536
    buffer_load_dwordx4 v[232:235], v40, s[64:67], s35 offen
    s_add_u32 s35, s35, 65536
    buffer_load_dwordx4 v[236:239], v40, s[64:67], s35 offen
    s_add_u32 s35, s35, 65536
    buffer_load_dwordx4 v[240:243], v40, s[64:67], s35 offen
    s_add_u32 s35, s35, 65536
    buffer_load_dwordx4 v[244:247], v40, s[64:67], s35 offen
    s_add_u32 s35, s35, 65536
    buffer_load_dwordx4 v[248:251], v40, s[64:67], s35 offen
    s_add_u32 s35, s35, 65536
    buffer_load_dwordx4 v[252:255], v40, s[64:67], s35 offen
    s_barrier
    s_add_u32 s68, s26, 1015808
    s_addc_u32 s69, s27, 0
    s_load_dword s62, s[68:69], 0
    s_mov_b32 s48, s26
    s_mov_b32 s49, s27
    s_mov_b32 s50, 0x280000
    s_mov_b32 s51, 0x20000
    s_add_u32 s36, s6, s63
    s_addc_u32 s37, s7, 0
    s_mov_b32 s38, 0x80000
    s_mov_b32 s39, 0x20000
    s_add_u32 s40, s8, s63
    s_addc_u32 s41, s9, 0
    s_mov_b32 s42, 0x80000
    s_mov_b32 s43, 0x20000
    v_mov_b64 v[44:45], 0
    ds_write_b64 v44, v[44:45] offset:2032
    ds_write_b64 v44, v[44:45] offset:2040
    v_mul_u32_u24 v46, 288, v29
    v_lshl_add_u32 v46, v43, 4, v46
    v_bfe_u32 v40, v0, 2, 2
    v_mul_u32_u24 v47, 288, v40
    v_lshl_add_u32 v47, v29, 4, v47
    v_lshlrev_b32 v41, 3, v29
    v_add_u32 v41, v41, v40
    v_lshlrev_b32 v41, 7, v41
    v_and_b32 v42, 3, v0
    v_lshl_add_u32 v41, v42, 3, v41
    v_lshlrev_b32 v44, 14, v29
    v_lshl_add_u32 v44, v43, 3, v44
    s_lshl_b32 s33, s29, 16
    s_lshl_b32 s34, s72, 12
    s_add_u32 s33, s33, s34
    s_lshl_b32 s34, s73, 9
    s_add_u32 s33, s33, s34
    s_add_u32 s33, s33, 2097152
    s_waitcnt vmcnt(16)
    v_lshlrev_b32 v144, 16, v128
    v_and_b32 v145, 0xffff0000, v128
    v_lshlrev_b32 v146, 16, v129
    v_and_b32 v147, 0xffff0000, v129
    v_lshlrev_b32 v148, 16, v130
    v_and_b32 v149, 0xffff0000, v130
    v_lshlrev_b32 v150, 16, v131
    v_and_b32 v151, 0xffff0000, v131
    v_lshlrev_b32 v152, 16, v132
    v_and_b32 v153, 0xffff0000, v132
    v_lshlrev_b32 v154, 16, v133
    v_and_b32 v155, 0xffff0000, v133
    v_lshlrev_b32 v156, 16, v134
    v_and_b32 v157, 0xffff0000, v134
    v_lshlrev_b32 v158, 16, v135
    v_and_b32 v159, 0xffff0000, v135
    v_lshlrev_b32 v160, 16, v136
    v_and_b32 v161, 0xffff0000, v136
    v_lshlrev_b32 v162, 16, v137
    v_and_b32 v163, 0xffff0000, v137
    v_lshlrev_b32 v164, 16, v138
    v_and_b32 v165, 0xffff0000, v138
    v_lshlrev_b32 v166, 16, v139
    v_and_b32 v167, 0xffff0000, v139
    v_lshlrev_b32 v168, 16, v140
    v_and_b32 v169, 0xffff0000, v140
    v_lshlrev_b32 v170, 16, v141
    v_and_b32 v171, 0xffff0000, v141
    v_lshlrev_b32 v172, 16, v142
    v_and_b32 v173, 0xffff0000, v142
    v_lshlrev_b32 v174, 16, v143
    v_and_b32 v175, 0xffff0000, v143
    v_pk_add_f32 v[10:11], v[144:145], v[146:147]
    v_pk_add_f32 v[16:17], v[148:149], v[150:151]
    v_pk_add_f32 v[10:11], v[10:11], v[152:153]
    v_pk_add_f32 v[16:17], v[16:17], v[154:155]
    v_pk_add_f32 v[10:11], v[10:11], v[156:157]
    v_pk_add_f32 v[16:17], v[16:17], v[158:159]
    v_pk_add_f32 v[10:11], v[10:11], v[160:161]
    v_pk_add_f32 v[16:17], v[16:17], v[162:163]
    v_pk_add_f32 v[10:11], v[10:11], v[164:165]
    v_pk_add_f32 v[16:17], v[16:17], v[166:167]
    v_pk_add_f32 v[10:11], v[10:11], v[168:169]
    v_pk_add_f32 v[16:17], v[16:17], v[170:171]
    v_pk_add_f32 v[10:11], v[10:11], v[172:173]
    v_pk_add_f32 v[16:17], v[16:17], v[174:175]
    v_pk_add_f32 v[10:11], v[10:11], v[16:17]
    v_add_f32 v10, v10, v11
    s_nop 1
    v_add_f32_dpp v10, v10, v10 quad_perm:[1,0,3,2] row_mask:0xf bank_mask:0xf
    s_nop 1
    v_add_f32_dpp v10, v10, v10 quad_perm:[2,3,0,1] row_mask:0xf bank_mask:0xf
    s_nop 1
    v_add_f32_dpp v10, v10, v10 row_half_mirror row_mask:0xf bank_mask:0xf
    s_nop 1
    v_add_f32_dpp v10, v10, v10 row_mirror row_mask:0xf bank_mask:0xf
    v_mul_f32 v14, 0x3b000000, v10
    v_sub_f32 v10, 0, v14
    v_mov_b32 v11, v10
    v_mov_b64 v[12:13], 0
    v_mov_b64 v[20:21], 0
    v_pk_add_f32 v[16:17], v[144:145], v[10:11]
    v_pk_add_f32 v[18:19], v[146:147], v[10:11]
    v_pk_fma_f32 v[12:13], v[16:17], v[16:17], v[12:13]
    v_pk_fma_f32 v[20:21], v[18:19], v[18:19], v[20:21]
    v_pk_add_f32 v[16:17], v[148:149], v[10:11]
    v_pk_add_f32 v[18:19], v[150:151], v[10:11]
    v_pk_fma_f32 v[12:13], v[16:17], v[16:17], v[12:13]
    v_pk_fma_f32 v[20:21], v[18:19], v[18:19], v[20:21]
    v_pk_add_f32 v[16:17], v[152:153], v[10:11]
    v_pk_add_f32 v[18:19], v[154:155], v[10:11]
    v_pk_fma_f32 v[12:13], v[16:17], v[16:17], v[12:13]
    v_pk_fma_f32 v[20:21], v[18:19], v[18:19], v[20:21]
    v_pk_add_f32 v[16:17], v[156:157], v[10:11]
    v_pk_add_f32 v[18:19], v[158:159], v[10:11]
    v_pk_fma_f32 v[12:13], v[16:17], v[16:17], v[12:13]
    v_pk_fma_f32 v[20:21], v[18:19], v[18:19], v[20:21]
    v_pk_add_f32 v[16:17], v[160:161], v[10:11]
    v_pk_add_f32 v[18:19], v[162:163], v[10:11]
    v_pk_fma_f32 v[12:13], v[16:17], v[16:17], v[12:13]
    v_pk_fma_f32 v[20:21], v[18:19], v[18:19], v[20:21]
    v_pk_add_f32 v[16:17], v[164:165], v[10:11]
    v_pk_add_f32 v[18:19], v[166:167], v[10:11]
    v_pk_fma_f32 v[12:13], v[16:17], v[16:17], v[12:13]
    v_pk_fma_f32 v[20:21], v[18:19], v[18:19], v[20:21]
    v_pk_add_f32 v[16:17], v[168:169], v[10:11]
    v_pk_add_f32 v[18:19], v[170:171], v[10:11]
    v_pk_fma_f32 v[12:13], v[16:17], v[16:17], v[12:13]
    v_pk_fma_f32 v[20:21], v[18:19], v[18:19], v[20:21]
    v_pk_add_f32 v[16:17], v[172:173], v[10:11]
    v_pk_add_f32 v[18:19], v[174:175], v[10:11]
    v_pk_fma_f32 v[12:13], v[16:17], v[16:17], v[12:13]
    v_pk_fma_f32 v[20:21], v[18:19], v[18:19], v[20:21]
    v_pk_add_f32 v[12:13], v[12:13], v[20:21]
    v_add_f32 v12, v12, v13
    s_nop 1
    v_add_f32_dpp v12, v12, v12 quad_perm:[1,0,3,2] row_mask:0xf bank_mask:0xf
    s_nop 1
    v_add_f32_dpp v12, v12, v12 quad_perm:[2,3,0,1] row_mask:0xf bank_mask:0xf
    s_nop 1
    v_add_f32_dpp v12, v12, v12 row_half_mirror row_mask:0xf bank_mask:0xf
    s_nop 1
    v_add_f32_dpp v12, v12, v12 row_mirror row_mask:0xf bank_mask:0xf
    v_mul_f32 v12, 0x3b000000, v12
    v_cvt_pk_bf16_f32 v12, v12, v12
    v_and_b32 v12, 0xffff0000, v12
    v_add_f32 v12, 0x3727c5ac, v12
    v_cvt_pk_bf16_f32 v12, v12, v12
    v_and_b32 v12, 0xffff0000, v12
    v_sqrt_f32 v12, v12
    s_nop 0
    v_cvt_pk_bf16_f32 v12, v12, v12
    v_and_b32 v12, 0xffff0000, v12
    v_rcp_f32 v12, v12
    v_cvt_pk_bf16_f32 v14, v14, v14
    v_and_b32 v14, 0xffff0000, v14
    v_sub_f32 v10, 0, v14
    v_mov_b32 v11, v10
    v_mov_b32 v13, v12
    s_cmp_eq_u32 s72, 1
    s_cbranch_scc0 L_q_nk1
    v_mov_b64 v[144:145], v[152:153]
    v_mov_b64 v[146:147], v[154:155]
    v_mov_b64 v[148:149], v[156:157]
    v_mov_b64 v[150:151], v[158:159]
L_q_nk1:
    s_cmp_eq_u32 s72, 2
    s_cbranch_scc0 L_q_nk2
    v_mov_b64 v[144:145], v[160:161]
    v_mov_b64 v[146:147], v[162:163]
    v_mov_b64 v[148:149], v[164:165]
    v_mov_b64 v[150:151], v[166:167]
L_q_nk2:
    s_cmp_eq_u32 s72, 3
    s_cbranch_scc0 L_q_nk3
    v_mov_b64 v[144:145], v[168:169]
    v_mov_b64 v[146:147], v[170:171]
    v_mov_b64 v[148:149], v[172:173]
    v_mov_b64 v[150:151], v[174:175]
L_q_nk3:
    v_pk_add_f32 v[144:145], v[144:145], v[10:11]
    v_cvt_pk_bf16_f32 v16, v144, v145
    v_pk_add_f32 v[146:147], v[146:147], v[10:11]
    v_cvt_pk_bf16_f32 v17, v146, v147
    v_pk_add_f32 v[148:149], v[148:149], v[10:11]
    v_cvt_pk_bf16_f32 v18, v148, v149
    v_pk_add_f32 v[150:151], v[150:151], v[10:11]
    v_cvt_pk_bf16_f32 v19, v150, v151
    v_lshlrev_b32 v144, 16, v16
    v_and_b32 v145, 0xffff0000, v16
    v_pk_mul_f32 v[144:145], v[144:145], v[12:13]
    v_cvt_pk_bf16_f32 v20, v144, v145
    v_lshlrev_b32 v146, 16, v17
    v_and_b32 v147, 0xffff0000, v17
    v_pk_mul_f32 v[146:147], v[146:147], v[12:13]
    v_cvt_pk_bf16_f32 v21, v146, v147
    v_lshlrev_b32 v148, 16, v18
    v_and_b32 v149, 0xffff0000, v18
    v_pk_mul_f32 v[148:149], v[148:149], v[12:13]
    v_cvt_pk_bf16_f32 v22, v148, v149
    v_lshlrev_b32 v150, 16, v19
    v_and_b32 v151, 0xffff0000, v19
    v_pk_mul_f32 v[150:151], v[150:151], v[12:13]
    v_cvt_pk_bf16_f32 v23, v150, v151
    ds_write_b128 v46, v[20:23] offset:18432
    s_waitcnt vmcnt(8)
    ds_write_b128 v48, v[192:195] offset:32768
    ds_write_b128 v48, v[196:199] offset:33792
    ds_write_b128 v48, v[200:203] offset:34816
    ds_write_b128 v48, v[204:207] offset:35840
    ds_write_b128 v48, v[208:211] offset:36864
    ds_write_b128 v48, v[212:215] offset:37888
    ds_write_b128 v48, v[216:219] offset:38912
    ds_write_b128 v48, v[220:223] offset:39936
    s_waitcnt vmcnt(0)
    ds_write_b128 v48, v[224:227] offset:40960
    ds_write_b128 v48, v[228:231] offset:41984
    ds_write_b128 v48, v[232:235] offset:43008
    ds_write_b128 v48, v[236:239] offset:44032
    ds_write_b128 v48, v[240:243] offset:45056
    ds_write_b128 v48, v[244:247] offset:46080
    ds_write_b128 v48, v[248:251] offset:47104
    ds_write_b128 v48, v[252:255] offset:48128
    s_waitcnt lgkmcnt(0)
    s_mul_i32 s61, s62, 0x9e3779b1
    s_add_u32 s61, s61, 0x7f4a7c15
    ds_read_b128 v[128:131], v47 offset:18432
    ds_read_b64_tr_b16 v[192:193], v41 offset:32768
    ds_read_b64_tr_b16 v[194:195], v41 offset:33280
    ds_read_b64_tr_b16 v[196:197], v41 offset:32800
    ds_read_b64_tr_b16 v[198:199], v41 offset:33312
    ds_read_b64_tr_b16 v[200:201], v41 offset:32832
    ds_read_b64_tr_b16 v[202:203], v41 offset:33344
    ds_read_b64_tr_b16 v[204:205], v41 offset:32864
    ds_read_b64_tr_b16 v[206:207], v41 offset:33376
    ds_read_b128 v[132:135], v47 offset:18496
    ds_read_b64_tr_b16 v[208:209], v41 offset:36864
    ds_read_b64_tr_b16 v[210:211], v41 offset:37376
    ds_read_b64_tr_b16 v[212:213], v41 offset:36896
    ds_read_b64_tr_b16 v[214:215], v41 offset:37408
    ds_read_b64_tr_b16 v[216:217], v41 offset:36928
    ds_read_b64_tr_b16 v[218:219], v41 offset:37440
    ds_read_b64_tr_b16 v[220:221], v41 offset:36960
    ds_read_b64_tr_b16 v[222:223], v41 offset:37472
    ds_read_b128 v[136:139], v47 offset:18560
    ds_read_b64_tr_b16 v[224:225], v41 offset:40960
    ds_read_b64_tr_b16 v[226:227], v41 offset:41472
    ds_read_b64_tr_b16 v[228:229], v41 offset:40992
    ds_read_b64_tr_b16 v[230:231], v41 offset:41504
    ds_read_b64_tr_b16 v[232:233], v41 offset:41024
    ds_read_b64_tr_b16 v[234:235], v41 offset:41536
    ds_read_b64_tr_b16 v[236:237], v41 offset:41056
    ds_read_b64_tr_b16 v[238:239], v41 offset:41568
    ds_read_b128 v[140:143], v47 offset:18624
    ds_read_b64_tr_b16 v[240:241], v41 offset:45056
    ds_read_b64_tr_b16 v[242:243], v41 offset:45568
    ds_read_b64_tr_b16 v[244:245], v41 offset:45088
    ds_read_b64_tr_b16 v[246:247], v41 offset:45600
    ds_read_b64_tr_b16 v[248:249], v41 offset:45120
    ds_read_b64_tr_b16 v[250:251], v41 offset:45632
    ds_read_b64_tr_b16 v[252:253], v41 offset:45152
    ds_read_b64_tr_b16 v[254:255], v41 offset:45664
    s_waitcnt lgkmcnt(15)
    v_mfma_f32_16x16x32_bf16 v[8:11], v[128:131], v[192:195], 0
    v_mfma_f32_16x16x32_bf16 v[12:15], v[128:131], v[196:199], 0
    v_mfma_f32_16x16x32_bf16 v[16:19], v[128:131], v[200:203], 0
    v_mfma_f32_16x16x32_bf16 v[20:23], v[128:131], v[204:207], 0
    s_waitcnt lgkmcnt(15)
    v_mfma_f32_16x16x32_bf16 v[8:11], v[132:135], v[208:211], v[8:11]
    v_mfma_f32_16x16x32_bf16 v[12:15], v[132:135], v[212:215], v[12:15]
    v_mfma_f32_16x16x32_bf16 v[16:19], v[132:135], v[216:219], v[16:19]
    v_mfma_f32_16x16x32_bf16 v[20:23], v[132:135], v[220:223], v[20:23]
    s_waitcnt lgkmcnt(9)
    v_mfma_f32_16x16x32_bf16 v[8:11], v[136:139], v[224:227], v[8:11]
    v_mfma_f32_16x16x32_bf16 v[12:15], v[136:139], v[228:231], v[12:15]
    v_mfma_f32_16x16x32_bf16 v[16:19], v[136:139], v[232:235], v[16:19]
    v_mfma_f32_16x16x32_bf16 v[20:23], v[136:139], v[236:239], v[20:23]
    s_waitcnt lgkmcnt(0)
    v_mfma_f32_16x16x32_bf16 v[8:11], v[140:143], v[240:243], v[8:11]
    v_mfma_f32_16x16x32_bf16 v[12:15], v[140:143], v[244:247], v[12:15]
    v_mfma_f32_16x16x32_bf16 v[16:19], v[140:143], v[248:251], v[16:19]
    v_mfma_f32_16x16x32_bf16 v[20:23], v[140:143], v[252:255], v[20:23]
    s_nop 4
    v_mov_b32 v9, s61
    v_mov_b32 v13, s61
    v_mov_b32 v17, s61
    v_mov_b32 v21, s61
    buffer_store_dwordx2 v[8:9], v44, s[48:51], s33 offen offset:0 sc1
    buffer_store_dwordx2 v[12:13], v44, s[48:51], s33 offen offset:128 sc1
    buffer_store_dwordx2 v[16:17], v44, s[48:51], s33 offen offset:256 sc1
    buffer_store_dwordx2 v[20:21], v44, s[48:51], s33 offen offset:384 sc1
    buffer_load_dwordx4 v[64:67], v1, s[36:39], s55 offen offset:0 nt
    buffer_load_dwordx4 v[68:71], v1, s[36:39], s55 offen offset:64 nt
    buffer_load_dwordx4 v[72:75], v1, s[36:39], s55 offen offset:128 nt
    buffer_load_dwordx4 v[76:79], v1, s[36:39], s55 offen offset:192 nt
    buffer_load_dwordx4 v[80:83], v2, s[40:43], s55 offen offset:0 nt
    buffer_load_dwordx4 v[84:87], v2, s[40:43], s55 offen offset:256 nt
    buffer_load_dwordx4 v[88:91], v2, s[40:43], s55 offen offset:512 nt
    buffer_load_dwordx4 v[92:95], v2, s[40:43], s55 offen offset:768 nt
    s_add_u32 s55, s55, 32768
    s_sleep 127
    s_sleep 13
    s_branch L_q_poll0
L_T5:
    s_setprio 3
    v_lshlrev_b32 v48, 4, v0
    s_waitcnt lgkmcnt(0)
    s_add_u32 s68, s26, 1015808
    s_addc_u32 s69, s27, 0
    s_load_dword s62, s[68:69], 0
    s_add_u32 s36, s6, s63
    s_addc_u32 s37, s7, 0
    s_mov_b32 s38, 0x80000
    s_mov_b32 s39, 0x20000
    s_add_u32 s40, s8, s63
    s_addc_u32 s41, s9, 0
    s_mov_b32 s42, 0x80000
    s_mov_b32 s43, 0x20000
    s_mov_b32 s48, s26
    s_mov_b32 s49, s27
    s_mov_b32 s50, 0x280000
    s_mov_b32 s51, 0x20000
    s_barrier
    buffer_load_dwordx4 v[64:67], v1, s[36:39], s55 offen offset:0 nt
    buffer_load_dwordx4 v[68:71], v1, s[36:39], s55 offen offset:64 nt
    buffer_load_dwordx4 v[72:75], v1, s[36:39], s55 offen offset:128 nt
    buffer_load_dwordx4 v[76:79], v1, s[36:39], s55 offen offset:192 nt
    buffer_load_dwordx4 v[80:83], v2, s[40:43], s55 offen offset:0 nt
    buffer_load_dwordx4 v[84:87], v2, s[40:43], s55 offen offset:256 nt
    buffer_load_dwordx4 v[88:91], v2, s[40:43], s55 offen offset:512 nt
    buffer_load_dwordx4 v[92:95], v2, s[40:43], s55 offen offset:768 nt
    s_add_u32 s55, s55, 32768
    s_waitcnt lgkmcnt(0)
    s_mul_i32 s61, s62, 0x9e3779b1
    s_add_u32 s61, s61, 0x7f4a7c15
    s_sleep 127
    s_sleep 73
L_q_poll0:
    s_lshl_b32 s33, s29, 16
    s_lshl_b32 s34, s30, 14
    s_add_u32 s33, s33, s34
    s_lshl_b32 s34, s57, 11
    s_add_u32 s33, s33, s34
    s_add_u32 s33, s33, 2097152
    s_add_u32 s35, s33, 4096
    s_add_u32 s34, s33, 8192
    s_add_u32 s60, s33, 12288
    s_mov_b32 s58, 0
L_q_poll:
    buffer_load_dwordx4 v[192:195], v48, s[48:51], s33 offen offset:0 sc1
    buffer_load_dwordx4 v[196:199], v48, s[48:51], s33 offen offset:1024 sc1
    buffer_load_dwordx4 v[200:203], v48, s[48:51], s35 offen offset:0 sc1
    buffer_load_dwordx4 v[204:207], v48, s[48:51], s35 offen offset:1024 sc1
    buffer_load_dwordx4 v[208:211], v48, s[48:51], s34 offen offset:0 sc1
    buffer_load_dwordx4 v[212:215], v48, s[48:51], s34 offen offset:1024 sc1
    buffer_load_dwordx4 v[216:219], v48, s[48:51], s60 offen offset:0 sc1
    buffer_load_dwordx4 v[220:223], v48, s[48:51], s60 offen offset:1024 sc1
    s_waitcnt vmcnt(0)
    v_max3_u32 v40, v193, v195, v197
    v_min3_u32 v41, v193, v195, v197
    v_max3_u32 v40, v40, v199, v201
    v_min3_u32 v41, v41, v199, v201
    v_max3_u32 v40, v40, v203, v205
    v_min3_u32 v41, v41, v203, v205
    v_max3_u32 v40, v40, v207, v209
    v_min3_u32 v41, v41, v207, v209
    v_max3_u32 v40, v40, v211, v213
    v_min3_u32 v41, v41, v211, v213
    v_max3_u32 v40, v40, v215, v217
    v_min3_u32 v41, v41, v215, v217
    v_max3_u32 v40, v40, v219, v221
    v_min3_u32 v41, v41, v219, v221
    v_max_u32 v40, v40, v223
    v_min_u32 v41, v41, v223
    v_xor_b32 v40, s61, v40
    v_xor_b32 v41, s61, v41
    v_or_b32 v40, v40, v41
    v_cmp_ne_u32 vcc, 0, v40
    s_add_u32 s58, s58, 1
    s_cmp_ge_u32 s58, 200000
    s_cbranch_scc1 L_q_ok
    s_cbranch_vccnz L_q_poll
L_q_ok:
    v_lshlrev_b32 v40, 2, v0
    s_lshl_b32 s33, s57, 9
    v_add_u32 v40, s33, v40
    v_add_f32 v192, v192, v200
    v_add_f32 v194, v194, v202
    v_add_f32 v208, v208, v216
    v_add_f32 v210, v210, v218
    v_add_f32 v192, v192, v208
    v_add_f32 v194, v194, v210
    v_cvt_pk_bf16_f32 v193, v192, v194
    ds_write_b32 v40, v193 offset:0
    v_add_f32 v196, v196, v204
    v_add_f32 v198, v198, v206
    v_add_f32 v212, v212, v220
    v_add_f32 v214, v214, v222
    v_add_f32 v196, v196, v212
    v_add_f32 v198, v198, v214
    v_cvt_pk_bf16_f32 v197, v196, v198
    ds_write_b32 v40, v197 offset:256
    v_and_b32 v28, 1, v0
    v_mov_b32 v35, 0xffff
    v_lshlrev_b32 v28, 4, v28
    v_lshlrev_b32 v35, v28, v35
    v_and_b32 v28, 2, v0
    v_cmp_eq_u32 vcc, 0, v28
    s_nop 1
    v_cndmask_b32 v3, 0, v35, vcc
    v_cndmask_b32 v4, v35, 0, vcc
    v_mov_b64 v[38:39], 0
    v_mov_b64 v[42:43], 0
    v_mov_b64 v[46:47], 0
    v_mov_b64 v[50:51], 0
    v_mov_b64 v[54:55], 0
    v_mov_b64 v[56:57], 0
    v_mov_b64 v[58:59], 0
    v_mov_b64 v[60:61], 0
    v_mov_b64 v[62:63], 0
    v_mov_b32 v5, 0xff800000
    v_mov_b32 v6, 0
    v_bfe_u32 v28, v0, 2, 2
    v_lshlrev_b32 v28, 8, v28
    v_lshrrev_b32 v29, 4, v0
    v_lshl_add_u32 v28, v29, 4, v28
    s_waitcnt lgkmcnt(0)
    s_barrier
    s_setprio 0
    ds_read_b128 v[8:11], v28 offset:0
    ds_read_b128 v[12:15], v28 offset:64
    ds_read_b128 v[16:19], v28 offset:128
    ds_read_b128 v[20:23], v28 offset:192
    buffer_load_dwordx4 v[96:99], v1, s[36:39], s55 offen offset:0 nt
    buffer_load_dwordx4 v[100:103], v1, s[36:39], s55 offen offset:64 nt
    buffer_load_dwordx4 v[104:107], v1, s[36:39], s55 offen offset:128 nt
    buffer_load_dwordx4 v[108:111], v1, s[36:39], s55 offen offset:192 nt
    buffer_load_dwordx4 v[112:115], v2, s[40:43], s55 offen offset:0 nt
    buffer_load_dwordx4 v[116:119], v2, s[40:43], s55 offen offset:256 nt
    buffer_load_dwordx4 v[120:123], v2, s[40:43], s55 offen offset:512 nt
    buffer_load_dwordx4 v[124:127], v2, s[40:43], s55 offen offset:768 nt
    s_add_u32 s55, s55, 32768
    buffer_load_dwordx4 v[128:131], v1, s[36:39], s55 offen offset:0 nt
    buffer_load_dwordx4 v[132:135], v1, s[36:39], s55 offen offset:64 nt
    buffer_load_dwordx4 v[136:139], v1, s[36:39], s55 offen offset:128 nt
    buffer_load_dwordx4 v[140:143], v1, s[36:39], s55 offen offset:192 nt
    buffer_load_dwordx4 v[144:147], v2, s[40:43], s55 offen offset:0 nt
    buffer_load_dwordx4 v[148:151], v2, s[40:43], s55 offen offset:256 nt
    buffer_load_dwordx4 v[152:155], v2, s[40:43], s55 offen offset:512 nt
    buffer_load_dwordx4 v[156:159], v2, s[40:43], s55 offen offset:768 nt
    s_add_u32 s55, s55, 32768
    buffer_load_dwordx4 v[160:163], v1, s[36:39], s55 offen offset:0 nt
    buffer_load_dwordx4 v[164:167], v1, s[36:39], s55 offen offset:64 nt
    buffer_load_dwordx4 v[168:171], v1, s[36:39], s55 offen offset:128 nt
    buffer_load_dwordx4 v[172:175], v1, s[36:39], s55 offen offset:192 nt
    buffer_load_dwordx4 v[176:179], v2, s[40:43], s55 offen offset:0 nt
    buffer_load_dwordx4 v[180:183], v2, s[40:43], s55 offen offset:256 nt
    buffer_load_dwordx4 v[184:187], v2, s[40:43], s55 offen offset:512 nt
    buffer_load_dwordx4 v[188:191], v2, s[40:43], s55 offen offset:768 nt
    s_add_u32 s55, s55, 32768
    s_branch L_B1_after
L_P:
    v_and_b32 v28, 1, v0
    v_mov_b32 v35, 0xffff
    v_lshlrev_b32 v28, 4, v28
    v_lshlrev_b32 v35, v28, v35
    v_and_b32 v28, 2, v0
    v_cmp_eq_u32 vcc, 0, v28
    s_nop 1
    v_cndmask_b32 v3, 0, v35, vcc
    v_cndmask_b32 v4, v35, 0, vcc
    v_mov_b64 v[38:39], 0
    v_mov_b64 v[42:43], 0
    v_mov_b64 v[46:47], 0
    v_mov_b64 v[50:51], 0
    v_mov_b64 v[54:55], 0
    v_mov_b64 v[56:57], 0
    v_mov_b64 v[58:59], 0
    v_mov_b64 v[60:61], 0
    v_mov_b64 v[62:63], 0
    v_mov_b32 v5, 0xff800000
    v_mov_b32 v6, 0
    v_bfe_u32 v28, v0, 2, 2
    v_lshlrev_b32 v28, 8, v28
    v_lshrrev_b32 v29, 4, v0
    v_lshl_add_u32 v28, v29, 4, v28
    s_waitcnt lgkmcnt(0)
    s_add_u32 s36, s6, s63
    s_addc_u32 s37, s7, 0
    s_mov_b32 s38, 0x80000
    s_mov_b32 s39, 0x20000
    s_add_u32 s40, s8, s63
    s_addc_u32 s41, s9, 0
    s_mov_b32 s42, 0x80000
    s_mov_b32 s43, 0x20000
    buffer_load_dwordx4 v[64:67], v1, s[36:39], s55 offen offset:0 nt
    buffer_load_dwordx4 v[68:71], v1, s[36:39], s55 offen offset:64 nt
    buffer_load_dwordx4 v[72:75], v1, s[36:39], s55 offen offset:128 nt
    buffer_load_dwordx4 v[76:79], v1, s[36:39], s55 offen offset:192 nt
    s_barrier
    s_mov_b32 s48, s26
    s_mov_b32 s49, s27
    s_mov_b32 s50, 0x280000
    s_mov_b32 s51, 0x20000
    s_waitcnt vmcnt(8)
    buffer_load_dwordx4 v[80:83], v2, s[40:43], s55 offen offset:0 nt
    buffer_load_dwordx4 v[84:87], v2, s[40:43], s55 offen offset:256 nt
    buffer_load_dwordx4 v[88:91], v2, s[40:43], s55 offen offset:512 nt
    buffer_load_dwordx4 v[92:95], v2, s[40:43], s55 offen offset:768 nt
    s_add_u32 s55, s55, 32768
    s_waitcnt vmcnt(8)
    buffer_load_dwordx4 v[96:99], v1, s[36:39], s55 offen offset:0 nt
    buffer_load_dwordx4 v[100:103], v1, s[36:39], s55 offen offset:64 nt
    buffer_load_dwordx4 v[104:107], v1, s[36:39], s55 offen offset:128 nt
    buffer_load_dwordx4 v[108:111], v1, s[36:39], s55 offen offset:192 nt
    s_waitcnt vmcnt(8)
    buffer_load_dwordx4 v[112:115], v2, s[40:43], s55 offen offset:0 nt
    buffer_load_dwordx4 v[116:119], v2, s[40:43], s55 offen offset:256 nt
    buffer_load_dwordx4 v[120:123], v2, s[40:43], s55 offen offset:512 nt
    buffer_load_dwordx4 v[124:127], v2, s[40:43], s55 offen offset:768 nt
    s_add_u32 s55, s55, 32768
    s_waitcnt vmcnt(8)
    buffer_load_dwordx4 v[128:131], v1, s[36:39], s55 offen offset:0 nt
    buffer_load_dwordx4 v[132:135], v1, s[36:39], s55 offen offset:64 nt
    buffer_load_dwordx4 v[136:139], v1, s[36:39], s55 offen offset:128 nt
    buffer_load_dwordx4 v[140:143], v1, s[36:39], s55 offen offset:192 nt
    s_waitcnt vmcnt(8)
    buffer_load_dwordx4 v[144:147], v2, s[40:43], s55 offen offset:0 nt
    buffer_load_dwordx4 v[148:151], v2, s[40:43], s55 offen offset:256 nt
    buffer_load_dwordx4 v[152:155], v2, s[40:43], s55 offen offset:512 nt
    buffer_load_dwordx4 v[156:159], v2, s[40:43], s55 offen offset:768 nt
    s_add_u32 s55, s55, 32768
    s_waitcnt vmcnt(8)
    buffer_load_dwordx4 v[160:163], v1, s[36:39], s55 offen offset:0 nt
    buffer_load_dwordx4 v[164:167], v1, s[36:39], s55 offen offset:64 nt
    buffer_load_dwordx4 v[168:171], v1, s[36:39], s55 offen offset:128 nt
    buffer_load_dwordx4 v[172:175], v1, s[36:39], s55 offen offset:192 nt
    s_waitcnt vmcnt(8)
    buffer_load_dwordx4 v[176:179], v2, s[40:43], s55 offen offset:0 nt
    buffer_load_dwordx4 v[180:183], v2, s[40:43], s55 offen offset:256 nt
    buffer_load_dwordx4 v[184:187], v2, s[40:43], s55 offen offset:512 nt
    buffer_load_dwordx4 v[188:191], v2, s[40:43], s55 offen offset:768 nt
    s_add_u32 s55, s55, 32768
    s_cmp_ge_u32 s28, 4
    s_cbranch_scc1 L_B1
    s_setprio 1
    s_cmp_lg_u32 s28, 1
    s_cbranch_scc1 L_B1
    v_lshlrev_b32 v32, 4, v0
    v_mov_b64 v[24:25], -1
    v_mov_b64 v[26:27], -1
    buffer_store_dwordx4 v[24:27], v32, s[48:51], s74 offen sc1
    s_mov_b64 exec, 1
    buffer_store_dwordx4 v[24:27], v32, s[48:51], s74 offen offset:1024 sc1
    s_mov_b64 exec, -1
    s_cmp_ge_u32 s2, 64
    s_cbranch_scc1 L_clr_notB
    v_lshrrev_b32 v30, 4, v0
    v_lshlrev_b32 v30, 14, v30
    v_and_b32 v31, 15, v0
    v_lshl_add_u32 v30, v31, 4, v30
    s_lshl_b32 s33, s29, 11
    s_lshl_b32 s34, s32, 8
    s_add_u32 s33, s33, s34
    s_add_u32 s33, s33, 327680
    buffer_store_dwordx4 v[24:27], v30, s[48:51], s33 offen sc1
L_clr_notB:
    s_sub_u32 s33, s2, 64
    s_cmp_ge_u32 s33, 56
    s_cbranch_scc1 L_B1
    s_lshl_b32 s33, s33, 13
    s_add_u32 s33, s33, 393216
    buffer_store_dwordx4 v[24:27], v32, s[48:51], s33 offen offset:0 sc1
    buffer_store_dwordx4 v[24:27], v32, s[48:51], s33 offen offset:1024 sc1
    buffer_store_dwordx4 v[24:27], v32, s[48:51], s33 offen offset:2048 sc1
    buffer_store_dwordx4 v[24:27], v32, s[48:51], s33 offen offset:3072 sc1
    s_add_u32 s33, s33, 4096
    buffer_store_dwordx4 v[24:27], v32, s[48:51], s33 offen offset:0 sc1
    buffer_store_dwordx4 v[24:27], v32, s[48:51], s33 offen offset:1024 sc1
    buffer_store_dwordx4 v[24:27], v32, s[48:51], s33 offen offset:2048 sc1
    buffer_store_dwordx4 v[24:27], v32, s[48:51], s33 offen offset:3072 sc1
L_B1:
    s_barrier
    ds_read_b128 v[8:11], v28 offset:0
    ds_read_b128 v[12:15], v28 offset:64
    ds_read_b128 v[16:19], v28 offset:128
    ds_read_b128 v[20:23], v28 offset:192
L_B1_after:
    s_mov_b32 s56, 0
    s_waitcnt lgkmcnt(0)
L_S_loop:
    s_waitcnt vmcnt(28)
    v_mfma_f32_16x16x32_bf16 v[24:27], v[64:67], v[8:11], 0
    v_mfma_f32_16x16x32_bf16 v[24:27], v[68:71], v[12:15], v[24:27]
    v_mfma_f32_16x16x32_bf16 v[24:27], v[72:75], v[16:19], v[24:27]
    v_mfma_f32_16x16x32_bf16 v[24:27], v[76:79], v[20:23], v[24:27]
    buffer_load_dwordx4 v[64:67], v1, s[36:39], s55 offen offset:0 nt
    buffer_load_dwordx4 v[68:71], v1, s[36:39], s55 offen offset:64 nt
    buffer_load_dwordx4 v[72:75], v1, s[36:39], s55 offen offset:128 nt
    buffer_load_dwordx4 v[76:79], v1, s[36:39], s55 offen offset:192 nt
    s_nop 3
    v_cvt_pk_bf16_f32 v28, v24, v25
    v_cvt_pk_bf16_f32 v29, v26, v27
    v_lshlrev_b32 v30, 16, v28
    v_and_b32 v31, 0xffff0000, v28
    v_lshlrev_b32 v32, 16, v29
    v_and_b32 v33, 0xffff0000, v29
    v_pk_mul_f32 v[30:31], v[30:31], s[98:99]
    v_pk_mul_f32 v[32:33], v[32:33], s[98:99]
    v_cvt_pk_bf16_f32 v28, v30, v31
    v_cvt_pk_bf16_f32 v29, v32, v33
    v_lshlrev_b32 v30, 16, v28
    v_and_b32 v31, 0xffff0000, v28
    v_lshlrev_b32 v32, 16, v29
    v_and_b32 v33, 0xffff0000, v29
    v_max3_f32 v34, v30, v31, v32
    v_max3_f32 v34, v34, v33, v5
    v_mov_b32 v35, v34
    s_nop 1
    v_permlane16_swap_b32 v34, v35
    v_max_f32 v34, v34, v35
    v_mov_b32 v35, v34
    s_nop 1
    v_permlane32_swap_b32 v34, v35
    v_max_f32 v34, v34, v35
    v_mul_f32 v7, s54, v34
    v_fma_f32 v36, v5, s53, v7
    v_fma_f32 v30, v30, s53, v7
    v_fma_f32 v31, v31, s53, v7
    v_fma_f32 v32, v32, s53, v7
    v_fma_f32 v33, v33, s53, v7
    v_exp_f32 v36, v36
    v_exp_f32 v30, v30
    v_exp_f32 v31, v31
    v_exp_f32 v32, v32
    v_exp_f32 v33, v33
    v_mov_b32 v5, v34
    v_mov_b32_dpp v37, v36 row_newbcast:0 row_mask:0x1 bank_mask:0xf
    s_nop 1
    v_mov_b32_dpp v37, v36 row_newbcast:4 row_mask:0x2 bank_mask:0xf
    s_nop 1
    v_mov_b32_dpp v37, v36 row_newbcast:8 row_mask:0x4 bank_mask:0xf
    s_nop 1
    v_mov_b32_dpp v37, v36 row_newbcast:12 row_mask:0x8 bank_mask:0xf
    v_fma_f32 v6, v6, v36, v30
    v_add_f32 v35, v31, v32
    v_add_f32 v6, v6, v33
    v_add_f32 v6, v6, v35
    v_cvt_pk_bf16_f32 v30, v30, v30
    v_cvt_pk_bf16_f32 v31, v31, v31
    v_cvt_pk_bf16_f32 v32, v32, v32
    v_cvt_pk_bf16_f32 v33, v33, v33
    v_mul_f32 v56, v56, v37
    v_mul_f32 v57, v57, v37
    v_mul_f32 v58, v58, v37
    v_mul_f32 v59, v59, v37
    v_mul_f32 v60, v60, v37
    v_mul_f32 v61, v61, v37
    v_mul_f32 v62, v62, v37
    v_mul_f32 v63, v63, v37
    v_and_b32 v40, v30, v3
    v_and_b32 v41, v30, v4
    v_and_b32 v44, v31, v3
    v_and_b32 v45, v31, v4
    v_and_b32 v48, v32, v3
    v_and_b32 v49, v32, v4
    v_and_b32 v52, v33, v3
    v_and_b32 v53, v33, v4
    s_waitcnt vmcnt(28)
    v_mfma_f32_16x16x32_bf16 v[56:59], v[40:43], v[80:83], v[56:59]
    v_mfma_f32_16x16x32_bf16 v[60:63], v[38:41], v[80:83], v[60:63]
    v_mfma_f32_16x16x32_bf16 v[56:59], v[44:47], v[84:87], v[56:59]
    v_mfma_f32_16x16x32_bf16 v[60:63], v[42:45], v[84:87], v[60:63]
    v_mfma_f32_16x16x32_bf16 v[56:59], v[48:51], v[88:91], v[56:59]
    v_mfma_f32_16x16x32_bf16 v[60:63], v[46:49], v[88:91], v[60:63]
    v_mfma_f32_16x16x32_bf16 v[56:59], v[52:55], v[92:95], v[56:59]
    v_mfma_f32_16x16x32_bf16 v[60:63], v[50:53], v[92:95], v[60:63]
    buffer_load_dwordx4 v[80:83], v2, s[40:43], s55 offen offset:0 nt
    buffer_load_dwordx4 v[84:87], v2, s[40:43], s55 offen offset:256 nt
    buffer_load_dwordx4 v[88:91], v2, s[40:43], s55 offen offset:512 nt
    buffer_load_dwordx4 v[92:95], v2, s[40:43], s55 offen offset:768 nt
    s_add_u32 s55, s55, 32768
    s_add_u32 s56, s56, 1
    s_waitcnt vmcnt(28)
    v_mfma_f32_16x16x32_bf16 v[24:27], v[96:99], v[8:11], 0
    v_mfma_f32_16x16x32_bf16 v[24:27], v[100:103], v[12:15], v[24:27]
    v_mfma_f32_16x16x32_bf16 v[24:27], v[104:107], v[16:19], v[24:27]
    v_mfma_f32_16x16x32_bf16 v[24:27], v[108:111], v[20:23], v[24:27]
    buffer_load_dwordx4 v[96:99], v1, s[36:39], s55 offen offset:0 nt
    buffer_load_dwordx4 v[100:103], v1, s[36:39], s55 offen offset:64 nt
    buffer_load_dwordx4 v[104:107], v1, s[36:39], s55 offen offset:128 nt
    buffer_load_dwordx4 v[108:111], v1, s[36:39], s55 offen offset:192 nt
    s_nop 3
    v_cvt_pk_bf16_f32 v28, v24, v25
    v_cvt_pk_bf16_f32 v29, v26, v27
    v_lshlrev_b32 v30, 16, v28
    v_and_b32 v31, 0xffff0000, v28
    v_lshlrev_b32 v32, 16, v29
    v_and_b32 v33, 0xffff0000, v29
    v_pk_mul_f32 v[30:31], v[30:31], s[98:99]
    v_pk_mul_f32 v[32:33], v[32:33], s[98:99]
    v_cvt_pk_bf16_f32 v28, v30, v31
    v_cvt_pk_bf16_f32 v29, v32, v33
    v_lshlrev_b32 v30, 16, v28
    v_and_b32 v31, 0xffff0000, v28
    v_lshlrev_b32 v32, 16, v29
    v_and_b32 v33, 0xffff0000, v29
    v_max3_f32 v34, v30, v31, v32
    v_max3_f32 v34, v34, v33, v5
    v_mov_b32 v35, v34
    s_nop 1
    v_permlane16_swap_b32 v34, v35
    v_max_f32 v34, v34, v35
    v_mov_b32 v35, v34
    s_nop 1
    v_permlane32_swap_b32 v34, v35
    v_max_f32 v34, v34, v35
    v_mul_f32 v7, s54, v34
    v_fma_f32 v36, v5, s53, v7
    v_fma_f32 v30, v30, s53, v7
    v_fma_f32 v31, v31, s53, v7
    v_fma_f32 v32, v32, s53, v7
    v_fma_f32 v33, v33, s53, v7
    v_exp_f32 v36, v36
    v_exp_f32 v30, v30
    v_exp_f32 v31, v31
    v_exp_f32 v32, v32
    v_exp_f32 v33, v33
    v_mov_b32 v5, v34
    v_mov_b32_dpp v37, v36 row_newbcast:0 row_mask:0x1 bank_mask:0xf
    s_nop 1
    v_mov_b32_dpp v37, v36 row_newbcast:4 row_mask:0x2 bank_mask:0xf
    s_nop 1
    v_mov_b32_dpp v37, v36 row_newbcast:8 row_mask:0x4 bank_mask:0xf
    s_nop 1
    v_mov_b32_dpp v37, v36 row_newbcast:12 row_mask:0x8 bank_mask:0xf
    v_fma_f32 v6, v6, v36, v30
    v_add_f32 v35, v31, v32
    v_add_f32 v6, v6, v33
    v_add_f32 v6, v6, v35
    v_cvt_pk_bf16_f32 v30, v30, v30
    v_cvt_pk_bf16_f32 v31, v31, v31
    v_cvt_pk_bf16_f32 v32, v32, v32
    v_cvt_pk_bf16_f32 v33, v33, v33
    v_mul_f32 v56, v56, v37
    v_mul_f32 v57, v57, v37
    v_mul_f32 v58, v58, v37
    v_mul_f32 v59, v59, v37
    v_mul_f32 v60, v60, v37
    v_mul_f32 v61, v61, v37
    v_mul_f32 v62, v62, v37
    v_mul_f32 v63, v63, v37
    v_and_b32 v40, v30, v3
    v_and_b32 v41, v30, v4
    v_and_b32 v44, v31, v3
    v_and_b32 v45, v31, v4
    v_and_b32 v48, v32, v3
    v_and_b32 v49, v32, v4
    v_and_b32 v52, v33, v3
    v_and_b32 v53, v33, v4
    s_waitcnt vmcnt(28)
    v_mfma_f32_16x16x32_bf16 v[56:59], v[40:43], v[112:115], v[56:59]
    v_mfma_f32_16x16x32_bf16 v[60:63], v[38:41], v[112:115], v[60:63]
    v_mfma_f32_16x16x32_bf16 v[56:59], v[44:47], v[116:119], v[56:59]
    v_mfma_f32_16x16x32_bf16 v[60:63], v[42:45], v[116:119], v[60:63]
    v_mfma_f32_16x16x32_bf16 v[56:59], v[48:51], v[120:123], v[56:59]
    v_mfma_f32_16x16x32_bf16 v[60:63], v[46:49], v[120:123], v[60:63]
    v_mfma_f32_16x16x32_bf16 v[56:59], v[52:55], v[124:127], v[56:59]
    v_mfma_f32_16x16x32_bf16 v[60:63], v[50:53], v[124:127], v[60:63]
    buffer_load_dwordx4 v[112:115], v2, s[40:43], s55 offen offset:0 nt
    buffer_load_dwordx4 v[116:119], v2, s[40:43], s55 offen offset:256 nt
    buffer_load_dwordx4 v[120:123], v2, s[40:43], s55 offen offset:512 nt
    buffer_load_dwordx4 v[124:127], v2, s[40:43], s55 offen offset:768 nt
    s_add_u32 s55, s55, 32768
    s_add_u32 s56, s56, 1
    s_waitcnt vmcnt(28)
    v_mfma_f32_16x16x32_bf16 v[24:27], v[128:131], v[8:11], 0
    v_mfma_f32_16x16x32_bf16 v[24:27], v[132:135], v[12:15], v[24:27]
    v_mfma_f32_16x16x32_bf16 v[24:27], v[136:139], v[16:19], v[24:27]
    v_mfma_f32_16x16x32_bf16 v[24:27], v[140:143], v[20:23], v[24:27]
    buffer_load_dwordx4 v[128:131], v1, s[36:39], s55 offen offset:0 nt
    buffer_load_dwordx4 v[132:135], v1, s[36:39], s55 offen offset:64 nt
    buffer_load_dwordx4 v[136:139], v1, s[36:39], s55 offen offset:128 nt
    buffer_load_dwordx4 v[140:143], v1, s[36:39], s55 offen offset:192 nt
    s_nop 3
    v_cvt_pk_bf16_f32 v28, v24, v25
    v_cvt_pk_bf16_f32 v29, v26, v27
    v_lshlrev_b32 v30, 16, v28
    v_and_b32 v31, 0xffff0000, v28
    v_lshlrev_b32 v32, 16, v29
    v_and_b32 v33, 0xffff0000, v29
    v_pk_mul_f32 v[30:31], v[30:31], s[98:99]
    v_pk_mul_f32 v[32:33], v[32:33], s[98:99]
    v_cvt_pk_bf16_f32 v28, v30, v31
    v_cvt_pk_bf16_f32 v29, v32, v33
    v_lshlrev_b32 v30, 16, v28
    v_and_b32 v31, 0xffff0000, v28
    v_lshlrev_b32 v32, 16, v29
    v_and_b32 v33, 0xffff0000, v29
    v_max3_f32 v34, v30, v31, v32
    v_max3_f32 v34, v34, v33, v5
    v_mov_b32 v35, v34
    s_nop 1
    v_permlane16_swap_b32 v34, v35
    v_max_f32 v34, v34, v35
    v_mov_b32 v35, v34
    s_nop 1
    v_permlane32_swap_b32 v34, v35
    v_max_f32 v34, v34, v35
    v_mul_f32 v7, s54, v34
    v_fma_f32 v36, v5, s53, v7
    v_fma_f32 v30, v30, s53, v7
    v_fma_f32 v31, v31, s53, v7
    v_fma_f32 v32, v32, s53, v7
    v_fma_f32 v33, v33, s53, v7
    v_exp_f32 v36, v36
    v_exp_f32 v30, v30
    v_exp_f32 v31, v31
    v_exp_f32 v32, v32
    v_exp_f32 v33, v33
    v_mov_b32 v5, v34
    v_mov_b32_dpp v37, v36 row_newbcast:0 row_mask:0x1 bank_mask:0xf
    s_nop 1
    v_mov_b32_dpp v37, v36 row_newbcast:4 row_mask:0x2 bank_mask:0xf
    s_nop 1
    v_mov_b32_dpp v37, v36 row_newbcast:8 row_mask:0x4 bank_mask:0xf
    s_nop 1
    v_mov_b32_dpp v37, v36 row_newbcast:12 row_mask:0x8 bank_mask:0xf
    v_fma_f32 v6, v6, v36, v30
    v_add_f32 v35, v31, v32
    v_add_f32 v6, v6, v33
    v_add_f32 v6, v6, v35
    v_cvt_pk_bf16_f32 v30, v30, v30
    v_cvt_pk_bf16_f32 v31, v31, v31
    v_cvt_pk_bf16_f32 v32, v32, v32
    v_cvt_pk_bf16_f32 v33, v33, v33
    v_mul_f32 v56, v56, v37
    v_mul_f32 v57, v57, v37
    v_mul_f32 v58, v58, v37
    v_mul_f32 v59, v59, v37
    v_mul_f32 v60, v60, v37
    v_mul_f32 v61, v61, v37
    v_mul_f32 v62, v62, v37
    v_mul_f32 v63, v63, v37
    v_and_b32 v40, v30, v3
    v_and_b32 v41, v30, v4
    v_and_b32 v44, v31, v3
    v_and_b32 v45, v31, v4
    v_and_b32 v48, v32, v3
    v_and_b32 v49, v32, v4
    v_and_b32 v52, v33, v3
    v_and_b32 v53, v33, v4
    s_waitcnt vmcnt(28)
    v_mfma_f32_16x16x32_bf16 v[56:59], v[40:43], v[144:147], v[56:59]
    v_mfma_f32_16x16x32_bf16 v[60:63], v[38:41], v[144:147], v[60:63]
    v_mfma_f32_16x16x32_bf16 v[56:59], v[44:47], v[148:151], v[56:59]
    v_mfma_f32_16x16x32_bf16 v[60:63], v[42:45], v[148:151], v[60:63]
    v_mfma_f32_16x16x32_bf16 v[56:59], v[48:51], v[152:155], v[56:59]
    v_mfma_f32_16x16x32_bf16 v[60:63], v[46:49], v[152:155], v[60:63]
    v_mfma_f32_16x16x32_bf16 v[56:59], v[52:55], v[156:159], v[56:59]
    v_mfma_f32_16x16x32_bf16 v[60:63], v[50:53], v[156:159], v[60:63]
    buffer_load_dwordx4 v[144:147], v2, s[40:43], s55 offen offset:0 nt
    buffer_load_dwordx4 v[148:151], v2, s[40:43], s55 offen offset:256 nt
    buffer_load_dwordx4 v[152:155], v2, s[40:43], s55 offen offset:512 nt
    buffer_load_dwordx4 v[156:159], v2, s[40:43], s55 offen offset:768 nt
    s_add_u32 s55, s55, 32768
    s_add_u32 s56, s56, 1
    s_waitcnt vmcnt(28)
    v_mfma_f32_16x16x32_bf16 v[24:27], v[160:163], v[8:11], 0
    v_mfma_f32_16x16x32_bf16 v[24:27], v[164:167], v[12:15], v[24:27]
    v_mfma_f32_16x16x32_bf16 v[24:27], v[168:171], v[16:19], v[24:27]
    v_mfma_f32_16x16x32_bf16 v[24:27], v[172:175], v[20:23], v[24:27]
    buffer_load_dwordx4 v[160:163], v1, s[36:39], s55 offen offset:0 nt
    buffer_load_dwordx4 v[164:167], v1, s[36:39], s55 offen offset:64 nt
    buffer_load_dwordx4 v[168:171], v1, s[36:39], s55 offen offset:128 nt
    buffer_load_dwordx4 v[172:175], v1, s[36:39], s55 offen offset:192 nt
    s_nop 3
    v_cvt_pk_bf16_f32 v28, v24, v25
    v_cvt_pk_bf16_f32 v29, v26, v27
    v_lshlrev_b32 v30, 16, v28
    v_and_b32 v31, 0xffff0000, v28
    v_lshlrev_b32 v32, 16, v29
    v_and_b32 v33, 0xffff0000, v29
    v_pk_mul_f32 v[30:31], v[30:31], s[98:99]
    v_pk_mul_f32 v[32:33], v[32:33], s[98:99]
    v_cvt_pk_bf16_f32 v28, v30, v31
    v_cvt_pk_bf16_f32 v29, v32, v33
    v_lshlrev_b32 v30, 16, v28
    v_and_b32 v31, 0xffff0000, v28
    v_lshlrev_b32 v32, 16, v29
    v_and_b32 v33, 0xffff0000, v29
    v_max3_f32 v34, v30, v31, v32
    v_max3_f32 v34, v34, v33, v5
    v_mov_b32 v35, v34
    s_nop 1
    v_permlane16_swap_b32 v34, v35
    v_max_f32 v34, v34, v35
    v_mov_b32 v35, v34
    s_nop 1
    v_permlane32_swap_b32 v34, v35
    v_max_f32 v34, v34, v35
    v_mul_f32 v7, s54, v34
    v_fma_f32 v36, v5, s53, v7
    v_fma_f32 v30, v30, s53, v7
    v_fma_f32 v31, v31, s53, v7
    v_fma_f32 v32, v32, s53, v7
    v_fma_f32 v33, v33, s53, v7
    v_exp_f32 v36, v36
    v_exp_f32 v30, v30
    v_exp_f32 v31, v31
    v_exp_f32 v32, v32
    v_exp_f32 v33, v33
    v_mov_b32 v5, v34
    v_mov_b32_dpp v37, v36 row_newbcast:0 row_mask:0x1 bank_mask:0xf
    s_nop 1
    v_mov_b32_dpp v37, v36 row_newbcast:4 row_mask:0x2 bank_mask:0xf
    s_nop 1
    v_mov_b32_dpp v37, v36 row_newbcast:8 row_mask:0x4 bank_mask:0xf
    s_nop 1
    v_mov_b32_dpp v37, v36 row_newbcast:12 row_mask:0x8 bank_mask:0xf
    v_fma_f32 v6, v6, v36, v30
    v_add_f32 v35, v31, v32
    v_add_f32 v6, v6, v33
    v_add_f32 v6, v6, v35
    v_cvt_pk_bf16_f32 v30, v30, v30
    v_cvt_pk_bf16_f32 v31, v31, v31
    v_cvt_pk_bf16_f32 v32, v32, v32
    v_cvt_pk_bf16_f32 v33, v33, v33
    v_mul_f32 v56, v56, v37
    v_mul_f32 v57, v57, v37
    v_mul_f32 v58, v58, v37
    v_mul_f32 v59, v59, v37
    v_mul_f32 v60, v60, v37
    v_mul_f32 v61, v61, v37
    v_mul_f32 v62, v62, v37
    v_mul_f32 v63, v63, v37
    v_and_b32 v40, v30, v3
    v_and_b32 v41, v30, v4
    v_and_b32 v44, v31, v3
    v_and_b32 v45, v31, v4
    v_and_b32 v48, v32, v3
    v_and_b32 v49, v32, v4
    v_and_b32 v52, v33, v3
    v_and_b32 v53, v33, v4
    s_waitcnt vmcnt(28)
    v_mfma_f32_16x16x32_bf16 v[56:59], v[40:43], v[176:179], v[56:59]
    v_mfma_f32_16x16x32_bf16 v[60:63], v[38:41], v[176:179], v[60:63]
    v_mfma_f32_16x16x32_bf16 v[56:59], v[44:47], v[180:183], v[56:59]
    v_mfma_f32_16x16x32_bf16 v[60:63], v[42:45], v[180:183], v[60:63]
    v_mfma_f32_16x16x32_bf16 v[56:59], v[48:51], v[184:187], v[56:59]
    v_mfma_f32_16x16x32_bf16 v[60:63], v[46:49], v[184:187], v[60:63]
    v_mfma_f32_16x16x32_bf16 v[56:59], v[52:55], v[188:191], v[56:59]
    v_mfma_f32_16x16x32_bf16 v[60:63], v[50:53], v[188:191], v[60:63]
    buffer_load_dwordx4 v[176:179], v2, s[40:43], s55 offen offset:0 nt
    buffer_load_dwordx4 v[180:183], v2, s[40:43], s55 offen offset:256 nt
    buffer_load_dwordx4 v[184:187], v2, s[40:43], s55 offen offset:512 nt
    buffer_load_dwordx4 v[188:191], v2, s[40:43], s55 offen offset:768 nt
    s_add_u32 s55, s55, 32768
    s_add_u32 s56, s56, 1
    s_cmp_eq_u32 s56, 4
    s_cbranch_scc0 L_noatom
    s_cmp_eq_u32 s28, 1
    s_cbranch_scc0 L_noatom
    v_mov_b32 v35, 1
    s_mov_b64 exec, 1
    global_atomic_add v38, v35, s[24:25] sc1
    s_mov_b64 exec, -1
L_noatom:
    s_cmp_eq_u32 s56, 12
    s_cbranch_scc1 L_S_drain
    s_branch L_S_loop
L_S_drain:
    v_mov_b32 v35, 1
    ds_add_u32 v38, v35 offset:2032
    s_waitcnt vmcnt(28)
    v_mfma_f32_16x16x32_bf16 v[24:27], v[64:67], v[8:11], 0
    v_mfma_f32_16x16x32_bf16 v[24:27], v[68:71], v[12:15], v[24:27]
    v_mfma_f32_16x16x32_bf16 v[24:27], v[72:75], v[16:19], v[24:27]
    v_mfma_f32_16x16x32_bf16 v[24:27], v[76:79], v[20:23], v[24:27]
    s_nop 7
    v_cvt_pk_bf16_f32 v28, v24, v25
    v_cvt_pk_bf16_f32 v29, v26, v27
    v_lshlrev_b32 v30, 16, v28
    v_and_b32 v31, 0xffff0000, v28
    v_lshlrev_b32 v32, 16, v29
    v_and_b32 v33, 0xffff0000, v29
    v_pk_mul_f32 v[30:31], v[30:31], s[98:99]
    v_pk_mul_f32 v[32:33], v[32:33], s[98:99]
    v_cvt_pk_bf16_f32 v28, v30, v31
    v_cvt_pk_bf16_f32 v29, v32, v33
    v_lshlrev_b32 v30, 16, v28
    v_and_b32 v31, 0xffff0000, v28
    v_lshlrev_b32 v32, 16, v29
    v_and_b32 v33, 0xffff0000, v29
    v_max3_f32 v34, v30, v31, v32
    v_max3_f32 v34, v34, v33, v5
    v_mov_b32 v35, v34
    s_nop 1
    v_permlane16_swap_b32 v34, v35
    v_max_f32 v34, v34, v35
    v_mov_b32 v35, v34
    s_nop 1
    v_permlane32_swap_b32 v34, v35
    v_max_f32 v34, v34, v35
    v_mul_f32 v7, s54, v34
    v_fma_f32 v36, v5, s53, v7
    v_fma_f32 v30, v30, s53, v7
    v_fma_f32 v31, v31, s53, v7
    v_fma_f32 v32, v32, s53, v7
    v_fma_f32 v33, v33, s53, v7
    v_exp_f32 v36, v36
    v_exp_f32 v30, v30
    v_exp_f32 v31, v31
    v_exp_f32 v32, v32
    v_exp_f32 v33, v33
    v_mov_b32 v5, v34
    v_mov_b32_dpp v37, v36 row_newbcast:0 row_mask:0x1 bank_mask:0xf
    s_nop 1
    v_mov_b32_dpp v37, v36 row_newbcast:4 row_mask:0x2 bank_mask:0xf
    s_nop 1
    v_mov_b32_dpp v37, v36 row_newbcast:8 row_mask:0x4 bank_mask:0xf
    s_nop 1
    v_mov_b32_dpp v37, v36 row_newbcast:12 row_mask:0x8 bank_mask:0xf
    v_fma_f32 v6, v6, v36, v30
    v_add_f32 v35, v31, v32
    v_add_f32 v6, v6, v33
    v_add_f32 v6, v6, v35
    v_cvt_pk_bf16_f32 v30, v30, v30
    v_cvt_pk_bf16_f32 v31, v31, v31
    v_cvt_pk_bf16_f32 v32, v32, v32
    v_cvt_pk_bf16_f32 v33, v33, v33
    v_mul_f32 v56, v56, v37
    v_mul_f32 v57, v57, v37
    v_mul_f32 v58, v58, v37
    v_mul_f32 v59, v59, v37
    v_mul_f32 v60, v60, v37
    v_mul_f32 v61, v61, v37
    v_mul_f32 v62, v62, v37
    v_mul_f32 v63, v63, v37
    v_and_b32 v40, v30, v3
    v_and_b32 v41, v30, v4
    v_and_b32 v44, v31, v3
    v_and_b32 v45, v31, v4
    v_and_b32 v48, v32, v3
    v_and_b32 v49, v32, v4
    v_and_b32 v52, v33, v3
    v_and_b32 v53, v33, v4
    s_waitcnt vmcnt(24)
    v_mfma_f32_16x16x32_bf16 v[56:59], v[40:43], v[80:83], v[56:59]
    v_mfma_f32_16x16x32_bf16 v[60:63], v[38:41], v[80:83], v[60:63]
    v_mfma_f32_16x16x32_bf16 v[56:59], v[44:47], v[84:87], v[56:59]
    v_mfma_f32_16x16x32_bf16 v[60:63], v[42:45], v[84:87], v[60:63]
    v_mfma_f32_16x16x32_bf16 v[56:59], v[48:51], v[88:91], v[56:59]
    v_mfma_f32_16x16x32_bf16 v[60:63], v[46:49], v[88:91], v[60:63]
    v_mfma_f32_16x16x32_bf16 v[56:59], v[52:55], v[92:95], v[56:59]
    v_mfma_f32_16x16x32_bf16 v[60:63], v[50:53], v[92:95], v[60:63]
    s_waitcnt vmcnt(20)
    v_mfma_f32_16x16x32_bf16 v[24:27], v[96:99], v[8:11], 0
    v_mfma_f32_16x16x32_bf16 v[24:27], v[100:103], v[12:15], v[24:27]
    v_mfma_f32_16x16x32_bf16 v[24:27], v[104:107], v[16:19], v[24:27]
    v_mfma_f32_16x16x32_bf16 v[24:27], v[108:111], v[20:23], v[24:27]
    s_nop 7
    v_cvt_pk_bf16_f32 v28, v24, v25
    v_cvt_pk_bf16_f32 v29, v26, v27
    v_lshlrev_b32 v30, 16, v28
    v_and_b32 v31, 0xffff0000, v28
    v_lshlrev_b32 v32, 16, v29
    v_and_b32 v33, 0xffff0000, v29
    v_pk_mul_f32 v[30:31], v[30:31], s[98:99]
    v_pk_mul_f32 v[32:33], v[32:33], s[98:99]
    v_cvt_pk_bf16_f32 v28, v30, v31
    v_cvt_pk_bf16_f32 v29, v32, v33
    v_lshlrev_b32 v30, 16, v28
    v_and_b32 v31, 0xffff0000, v28
    v_lshlrev_b32 v32, 16, v29
    v_and_b32 v33, 0xffff0000, v29
    v_max3_f32 v34, v30, v31, v32
    v_max3_f32 v34, v34, v33, v5
    v_mov_b32 v35, v34
    s_nop 1
    v_permlane16_swap_b32 v34, v35
    v_max_f32 v34, v34, v35
    v_mov_b32 v35, v34
    s_nop 1
    v_permlane32_swap_b32 v34, v35
    v_max_f32 v34, v34, v35
    v_mul_f32 v7, s54, v34
    v_fma_f32 v36, v5, s53, v7
    v_fma_f32 v30, v30, s53, v7
    v_fma_f32 v31, v31, s53, v7
    v_fma_f32 v32, v32, s53, v7
    v_fma_f32 v33, v33, s53, v7
    v_exp_f32 v36, v36
    v_exp_f32 v30, v30
    v_exp_f32 v31, v31
    v_exp_f32 v32, v32
    v_exp_f32 v33, v33
    v_mov_b32 v5, v34
    v_mov_b32_dpp v37, v36 row_newbcast:0 row_mask:0x1 bank_mask:0xf
    s_nop 1
    v_mov_b32_dpp v37, v36 row_newbcast:4 row_mask:0x2 bank_mask:0xf
    s_nop 1
    v_mov_b32_dpp v37, v36 row_newbcast:8 row_mask:0x4 bank_mask:0xf
    s_nop 1
    v_mov_b32_dpp v37, v36 row_newbcast:12 row_mask:0x8 bank_mask:0xf
    v_fma_f32 v6, v6, v36, v30
    v_add_f32 v35, v31, v32
    v_add_f32 v6, v6, v33
    v_add_f32 v6, v6, v35
    v_cvt_pk_bf16_f32 v30, v30, v30
    v_cvt_pk_bf16_f32 v31, v31, v31
    v_cvt_pk_bf16_f32 v32, v32, v32
    v_cvt_pk_bf16_f32 v33, v33, v33
    v_mul_f32 v56, v56, v37
    v_mul_f32 v57, v57, v37
    v_mul_f32 v58, v58, v37
    v_mul_f32 v59, v59, v37
    v_mul_f32 v60, v60, v37
    v_mul_f32 v61, v61, v37
    v_mul_f32 v62, v62, v37
    v_mul_f32 v63, v63, v37
    v_and_b32 v40, v30, v3
    v_and_b32 v41, v30, v4
    v_and_b32 v44, v31, v3
    v_and_b32 v45, v31, v4
    v_and_b32 v48, v32, v3
    v_and_b32 v49, v32, v4
    v_and_b32 v52, v33, v3
    v_and_b32 v53, v33, v4
    s_waitcnt vmcnt(16)
    v_mfma_f32_16x16x32_bf16 v[56:59], v[40:43], v[112:115], v[56:59]
    v_mfma_f32_16x16x32_bf16 v[60:63], v[38:41], v[112:115], v[60:63]
    v_mfma_f32_16x16x32_bf16 v[56:59], v[44:47], v[116:119], v[56:59]
    v_mfma_f32_16x16x32_bf16 v[60:63], v[42:45], v[116:119], v[60:63]
    v_mfma_f32_16x16x32_bf16 v[56:59], v[48:51], v[120:123], v[56:59]
    v_mfma_f32_16x16x32_bf16 v[60:63], v[46:49], v[120:123], v[60:63]
    v_mfma_f32_16x16x32_bf16 v[56:59], v[52:55], v[124:127], v[56:59]
    v_mfma_f32_16x16x32_bf16 v[60:63], v[50:53], v[124:127], v[60:63]
    s_waitcnt vmcnt(12)
    v_mfma_f32_16x16x32_bf16 v[24:27], v[128:131], v[8:11], 0
    v_mfma_f32_16x16x32_bf16 v[24:27], v[132:135], v[12:15], v[24:27]
    v_mfma_f32_16x16x32_bf16 v[24:27], v[136:139], v[16:19], v[24:27]
    v_mfma_f32_16x16x32_bf16 v[24:27], v[140:143], v[20:23], v[24:27]
    s_nop 7
    v_cvt_pk_bf16_f32 v28, v24, v25
    v_cvt_pk_bf16_f32 v29, v26, v27
    v_lshlrev_b32 v30, 16, v28
    v_and_b32 v31, 0xffff0000, v28
    v_lshlrev_b32 v32, 16, v29
    v_and_b32 v33, 0xffff0000, v29
    v_pk_mul_f32 v[30:31], v[30:31], s[98:99]
    v_pk_mul_f32 v[32:33], v[32:33], s[98:99]
    v_cvt_pk_bf16_f32 v28, v30, v31
    v_cvt_pk_bf16_f32 v29, v32, v33
    v_lshlrev_b32 v30, 16, v28
    v_and_b32 v31, 0xffff0000, v28
    v_lshlrev_b32 v32, 16, v29
    v_and_b32 v33, 0xffff0000, v29
    v_max3_f32 v34, v30, v31, v32
    v_max3_f32 v34, v34, v33, v5
    v_mov_b32 v35, v34
    s_nop 1
    v_permlane16_swap_b32 v34, v35
    v_max_f32 v34, v34, v35
    v_mov_b32 v35, v34
    s_nop 1
    v_permlane32_swap_b32 v34, v35
    v_max_f32 v34, v34, v35
    v_mul_f32 v7, s54, v34
    v_fma_f32 v36, v5, s53, v7
    v_fma_f32 v30, v30, s53, v7
    v_fma_f32 v31, v31, s53, v7
    v_fma_f32 v32, v32, s53, v7
    v_fma_f32 v33, v33, s53, v7
    v_exp_f32 v36, v36
    v_exp_f32 v30, v30
    v_exp_f32 v31, v31
    v_exp_f32 v32, v32
    v_exp_f32 v33, v33
    v_mov_b32 v5, v34
    v_mov_b32_dpp v37, v36 row_newbcast:0 row_mask:0x1 bank_mask:0xf
    s_nop 1
    v_mov_b32_dpp v37, v36 row_newbcast:4 row_mask:0x2 bank_mask:0xf
    s_nop 1
    v_mov_b32_dpp v37, v36 row_newbcast:8 row_mask:0x4 bank_mask:0xf
    s_nop 1
    v_mov_b32_dpp v37, v36 row_newbcast:12 row_mask:0x8 bank_mask:0xf
    v_fma_f32 v6, v6, v36, v30
    v_add_f32 v35, v31, v32
    v_add_f32 v6, v6, v33
    v_add_f32 v6, v6, v35
    v_cvt_pk_bf16_f32 v30, v30, v30
    v_cvt_pk_bf16_f32 v31, v31, v31
    v_cvt_pk_bf16_f32 v32, v32, v32
    v_cvt_pk_bf16_f32 v33, v33, v33
    v_mul_f32 v56, v56, v37
    v_mul_f32 v57, v57, v37
    v_mul_f32 v58, v58, v37
    v_mul_f32 v59, v59, v37
    v_mul_f32 v60, v60, v37
    v_mul_f32 v61, v61, v37
    v_mul_f32 v62, v62, v37
    v_mul_f32 v63, v63, v37
    v_and_b32 v40, v30, v3
    v_and_b32 v41, v30, v4
    v_and_b32 v44, v31, v3
    v_and_b32 v45, v31, v4
    v_and_b32 v48, v32, v3
    v_and_b32 v49, v32, v4
    v_and_b32 v52, v33, v3
    v_and_b32 v53, v33, v4
    s_waitcnt vmcnt(8)
    v_mfma_f32_16x16x32_bf16 v[56:59], v[40:43], v[144:147], v[56:59]
    v_mfma_f32_16x16x32_bf16 v[60:63], v[38:41], v[144:147], v[60:63]
    v_mfma_f32_16x16x32_bf16 v[56:59], v[44:47], v[148:151], v[56:59]
    v_mfma_f32_16x16x32_bf16 v[60:63], v[42:45], v[148:151], v[60:63]
    v_mfma_f32_16x16x32_bf16 v[56:59], v[48:51], v[152:155], v[56:59]
    v_mfma_f32_16x16x32_bf16 v[60:63], v[46:49], v[152:155], v[60:63]
    v_mfma_f32_16x16x32_bf16 v[56:59], v[52:55], v[156:159], v[56:59]
    v_mfma_f32_16x16x32_bf16 v[60:63], v[50:53], v[156:159], v[60:63]
    s_waitcnt vmcnt(4)
    v_mfma_f32_16x16x32_bf16 v[24:27], v[160:163], v[8:11], 0
    v_mfma_f32_16x16x32_bf16 v[24:27], v[164:167], v[12:15], v[24:27]
    v_mfma_f32_16x16x32_bf16 v[24:27], v[168:171], v[16:19], v[24:27]
    v_mfma_f32_16x16x32_bf16 v[24:27], v[172:175], v[20:23], v[24:27]
    s_nop 7
    v_cvt_pk_bf16_f32 v28, v24, v25
    v_cvt_pk_bf16_f32 v29, v26, v27
    v_lshlrev_b32 v30, 16, v28
    v_and_b32 v31, 0xffff0000, v28
    v_lshlrev_b32 v32, 16, v29
    v_and_b32 v33, 0xffff0000, v29
    v_pk_mul_f32 v[30:31], v[30:31], s[98:99]
    v_pk_mul_f32 v[32:33], v[32:33], s[98:99]
    v_cvt_pk_bf16_f32 v28, v30, v31
    v_cvt_pk_bf16_f32 v29, v32, v33
    v_lshlrev_b32 v30, 16, v28
    v_and_b32 v31, 0xffff0000, v28
    v_lshlrev_b32 v32, 16, v29
    v_and_b32 v33, 0xffff0000, v29
    v_max3_f32 v34, v30, v31, v32
    v_max3_f32 v34, v34, v33, v5
    v_mov_b32 v35, v34
    s_nop 1
    v_permlane16_swap_b32 v34, v35
    v_max_f32 v34, v34, v35
    v_mov_b32 v35, v34
    s_nop 1
    v_permlane32_swap_b32 v34, v35
    v_max_f32 v34, v34, v35
    v_mul_f32 v7, s54, v34
    v_fma_f32 v36, v5, s53, v7
    v_fma_f32 v30, v30, s53, v7
    v_fma_f32 v31, v31, s53, v7
    v_fma_f32 v32, v32, s53, v7
    v_fma_f32 v33, v33, s53, v7
    v_exp_f32 v36, v36
    v_exp_f32 v30, v30
    v_exp_f32 v31, v31
    v_exp_f32 v32, v32
    v_exp_f32 v33, v33
    v_mov_b32 v5, v34
    v_mov_b32_dpp v37, v36 row_newbcast:0 row_mask:0x1 bank_mask:0xf
    s_nop 1
    v_mov_b32_dpp v37, v36 row_newbcast:4 row_mask:0x2 bank_mask:0xf
    s_nop 1
    v_mov_b32_dpp v37, v36 row_newbcast:8 row_mask:0x4 bank_mask:0xf
    s_nop 1
    v_mov_b32_dpp v37, v36 row_newbcast:12 row_mask:0x8 bank_mask:0xf
    v_fma_f32 v6, v6, v36, v30
    v_add_f32 v35, v31, v32
    v_add_f32 v6, v6, v33
    v_add_f32 v6, v6, v35
    v_cvt_pk_bf16_f32 v30, v30, v30
    v_cvt_pk_bf16_f32 v31, v31, v31
    v_cvt_pk_bf16_f32 v32, v32, v32
    v_cvt_pk_bf16_f32 v33, v33, v33
    v_mul_f32 v56, v56, v37
    v_mul_f32 v57, v57, v37
    v_mul_f32 v58, v58, v37
    v_mul_f32 v59, v59, v37
    v_mul_f32 v60, v60, v37
    v_mul_f32 v61, v61, v37
    v_mul_f32 v62, v62, v37
    v_mul_f32 v63, v63, v37
    v_and_b32 v40, v30, v3
    v_and_b32 v41, v30, v4
    v_and_b32 v44, v31, v3
    v_and_b32 v45, v31, v4
    v_and_b32 v48, v32, v3
    v_and_b32 v49, v32, v4
    v_and_b32 v52, v33, v3
    v_and_b32 v53, v33, v4
    s_waitcnt vmcnt(0)
    v_mfma_f32_16x16x32_bf16 v[56:59], v[40:43], v[176:179], v[56:59]
    v_mfma_f32_16x16x32_bf16 v[60:63], v[38:41], v[176:179], v[60:63]
    v_mfma_f32_16x16x32_bf16 v[56:59], v[44:47], v[180:183], v[56:59]
    v_mfma_f32_16x16x32_bf16 v[60:63], v[42:45], v[180:183], v[60:63]
    v_mfma_f32_16x16x32_bf16 v[56:59], v[48:51], v[184:187], v[56:59]
    v_mfma_f32_16x16x32_bf16 v[60:63], v[46:49], v[184:187], v[60:63]
    v_mfma_f32_16x16x32_bf16 v[56:59], v[52:55], v[188:191], v[56:59]
    v_mfma_f32_16x16x32_bf16 v[60:63], v[50:53], v[188:191], v[60:63]
    v_mov_b32 v35, v6
    s_nop 1
    v_permlane16_swap_b32 v6, v35
    v_add_f32 v6, v6, v35
    v_lshrrev_b32 v28, 4, v0
    v_lshlrev_b32 v28, 9, v28
    v_and_b32 v29, 15, v0
    v_mov_b32 v35, v6
    s_nop 1
    v_permlane32_swap_b32 v6, v35
    v_add_f32 v6, v6, v35
    v_lshl_add_u32 v28, v29, 5, v28
    s_lshl_b32 s33, s28, 11
    v_add_u32 v28, s33, v28
    v_lshlrev_b32 v30, 3, v0
    s_lshl_b32 s33, s28, 2
    v_add_u32 v30, s33, v30
    ds_write_b128 v28, v[56:59] offset:2048
    ds_write_b128 v28, v[60:63] offset:2064
    s_mov_b32 exec_lo, 0x1111
    s_mov_b32 exec_hi, 0x0
    ds_write_b32 v30, v5 offset:1024
    ds_write_b32 v30, v6 offset:1152
    s_mov_b64 exec, -1
    v_mov_b32 v35, 1
    ds_add_u32 v38, v35 offset:2036
    s_cmp_lt_u32 s28, 4
    s_cbranch_scc1 L_A2
    s_setprio 3
    s_lshl_b32 s34, s57, 8
    s_add_u32 s35, s74, s34
    s_lshl_b32 s34, s57, 2
    s_add_u32 s60, s74, s34
    v_lshlrev_b32 v40, 3, v0
    s_lshl_b32 s33, s57, 9
    v_add_u32 v40, s33, v40
    s_lshl_b32 s33, s57, 5
    v_mov_b32 v41, s33
    v_lshlrev_b32 v48, 2, v0
    v_mov_b32 v49, 0
    s_mov_b32 s58, 0
L_T_f2:
    ds_read_b32 v50, v49 offset:2036
    s_waitcnt lgkmcnt(0)
    v_readfirstlane_b32 s72, v50
    s_add_u32 s58, s58, 1
    s_cmp_ge_u32 s58, 1600000
    s_cbranch_scc1 L_T_f2_ok
    s_cmp_eq_u32 s72, 512
    s_cbranch_scc1 L_T_f2_ok
    s_branch L_T_f2
L_T_f2_ok:
    ds_read_b128 v[24:27], v41 offset:1024
    ds_read_b128 v[28:31], v41 offset:1040
    ds_read_b128 v[32:35], v41 offset:1152
    ds_read_b128 v[36:39], v41 offset:1168
    ds_read_b64 v[8:9], v40 offset:2048
    ds_read_b64 v[10:11], v40 offset:4096
    ds_read_b64 v[12:13], v40 offset:6144
    ds_read_b64 v[14:15], v40 offset:8192
    ds_read_b64 v[16:17], v40 offset:10240
    ds_read_b64 v[18:19], v40 offset:12288
    ds_read_b64 v[20:21], v40 offset:14336
    ds_read_b64 v[22:23], v40 offset:16384
    s_waitcnt lgkmcnt(10)
    v_max3_f32 v42, v24, v25, v26
    v_max3_f32 v43, v27, v28, v29
    v_max3_f32 v42, v42, v30, v31
    v_max_f32 v42, v42, v43
    v_mul_f32 v43, s54, v42
    v_fma_f32 v24, v24, s53, v43
    v_fma_f32 v25, v25, s53, v43
    v_fma_f32 v26, v26, s53, v43
    v_fma_f32 v27, v27, s53, v43
    v_fma_f32 v28, v28, s53, v43
    v_fma_f32 v29, v29, s53, v43
    v_fma_f32 v30, v30, s53, v43
    v_fma_f32 v31, v31, s53, v43
    v_exp_f32 v24, v24
    v_exp_f32 v25, v25
    v_exp_f32 v26, v26
    v_exp_f32 v27, v27
    v_exp_f32 v28, v28
    v_exp_f32 v29, v29
    v_exp_f32 v30, v30
    v_exp_f32 v31, v31
    s_waitcnt lgkmcnt(8)
    v_pk_mul_f32 v[44:45], v[24:25], v[32:33]
    v_pk_fma_f32 v[44:45], v[26:27], v[34:35], v[44:45]
    v_pk_fma_f32 v[44:45], v[28:29], v[36:37], v[44:45]
    v_pk_fma_f32 v[44:45], v[30:31], v[38:39], v[44:45]
    s_waitcnt lgkmcnt(0)
    v_add_f32 v44, v44, v45
    v_mul_f32 v46, v24, v8
    v_mul_f32 v47, v24, v9
    v_rcp_f32 v45, v44
    v_log_f32 v44, v44
    v_fmac_f32 v46, v25, v10
    v_fmac_f32 v47, v25, v11
    v_fmac_f32 v46, v26, v12
    v_fmac_f32 v47, v26, v13
    v_fmac_f32 v46, v27, v14
    v_fmac_f32 v47, v27, v15
    v_fmac_f32 v46, v28, v16
    v_fmac_f32 v47, v28, v17
    v_fmac_f32 v46, v29, v18
    v_fmac_f32 v47, v29, v19
    v_fmac_f32 v46, v30, v20
    v_fmac_f32 v47, v30, v21
    v_fmac_f32 v46, v31, v22
    v_fmac_f32 v47, v31, v23
    v_sub_f32 v44, v44, v43
    v_mul_f32 v46, v46, v45
    v_mul_f32 v47, v47, v45
    v_cvt_pk_bf16_f32 v46, v46, v47
    s_nop 1
    v_mov_b32_dpp v8, v46 quad_perm:[0,0,0,0] row_mask:0xf bank_mask:0xf
    v_mov_b32_dpp v9, v46 quad_perm:[1,1,1,1] row_mask:0xf bank_mask:0xf
    v_mov_b32_dpp v10, v46 quad_perm:[2,2,2,2] row_mask:0xf bank_mask:0xf
    v_mov_b32_dpp v11, v46 quad_perm:[3,3,3,3] row_mask:0xf bank_mask:0xf
    s_mov_b32 exec_lo, 0x11111111
    s_mov_b32 exec_hi, 0x11111111
    buffer_store_dwordx4 v[8:11], v48, s[48:51], s35 offen sc1
    s_mov_b64 exec, 1
    buffer_store_dword v44, v49, s[48:51], s60 offen offset:1024 sc1
    s_mov_b64 exec, -1
    v_mov_b32 v50, 1
    ds_add_u32 v49, v50 offset:2044
    s_endpgm
L_A2:
    s_cmp_lg_u32 s28, 0
    s_cbranch_scc1 L_rk_wait
    v_mov_b32 v40, 128
    v_mov_b32 v41, 1
    s_mov_b64 exec, 1
    global_atomic_add v42, v40, v41, s[24:25] sc0 sc1
    s_waitcnt vmcnt(0)
    v_add_u32 v42, 1, v42
    v_mov_b32 v40, 0
    ds_write_b32 v40, v42 offset:2040
    s_mov_b64 exec, -1
L_rk_wait:
    v_mov_b32 v40, 0
    s_mov_b32 s58, 0
L_rk:
    ds_read_b32 v41, v40 offset:2040
    s_waitcnt lgkmcnt(0)
    v_readfirstlane_b32 s75, v41
    s_add_u32 s58, s58, 1
    s_cmp_ge_u32 s58, 1600000
    s_cbranch_scc1 L_end
    s_cmp_lg_u32 s75, 0
    s_cbranch_scc1 L_rk_ok
    s_sleep 4
    s_branch L_rk
L_rk_ok:
    s_sub_u32 s75, s75, 1
    s_sub_u32 s33, s75, 0
    s_cmp_lt_u32 s33, 56
    s_cbranch_scc0 L_rk_nc
    s_add_u32 s75, s33, 64
    s_branch L_rk_map
L_rk_nc:
    s_sub_u32 s33, s75, 56
    s_cmp_lt_u32 s33, 64
    s_cbranch_scc0 L_rk_nb
    s_mov_b32 s75, s33
    s_branch L_rk_map
L_rk_nb:
    s_sub_u32 s33, s75, 120
    s_cmp_lt_u32 s33, 32
    s_add_u32 s75, s33, 120
    s_cmp_lt_u32 s33, 32
    s_cbranch_scc1 L_rk_map
    s_mov_b32 s75, 255
L_rk_map:
    s_and_b32 s29, s75, 7
    s_lshr_b32 s32, s75, 3
    s_cmp_lt_u32 s75, 64
    s_cbranch_scc1 L_roleB
    s_sub_u32 s60, s75, 64
    s_cmp_lt_u32 s60, 56
    s_cbranch_scc1 L_roleC
    s_sub_u32 s60, s75, 120
    s_cmp_lt_u32 s60, 32
    s_cbranch_scc1 L_roleD
    s_endpgm
L_roleB:
    s_mov_b32 s58, 0
    v_mov_b32 v40, 0
L_cntB:
    global_load_dword v41, v40, s[24:25] sc1
    s_waitcnt vmcnt(0)
    v_readfirstlane_b32 s72, v41
    s_add_u32 s58, s58, 1
    s_cmp_ge_u32 s58, 200000
    s_cbranch_scc1 L_cntB_ok
    s_cmp_ge_u32 s72, 256
    s_cbranch_scc1 L_cntB_ok
    s_sleep 32
    s_branch L_cntB
L_cntB_ok:
    s_lshl_b32 s35, s29, 19
    s_lshl_b32 s34, s28, 17
    s_add_u32 s35, s35, s34
    s_lshl_b32 s34, s32, 7
    s_add_u32 s35, s35, s34
    s_add_u32 s44, s12, s35
    s_addc_u32 s45, s13, 0
    s_mov_b32 s46, 0x1fc80
    s_mov_b32 s47, 0x20000
    v_lshrrev_b32 v44, 3, v0
    v_lshlrev_b32 v44, 10, v44
    v_and_b32 v45, 7, v0
    v_lshl_add_u32 v44, v45, 4, v44
    s_lshl_b32 s59, s28, 14
    s_add_u32 s59, s59, 32768
    v_lshlrev_b32 v51, 4, v0
    v_add_u32 v45, s59, v51
    v_lshrrev_b32 v40, 4, v0
    v_bfe_u32 v41, v0, 2, 2
    v_lshl_add_u32 v42, v40, 3, v41
    v_lshlrev_b32 v42, 7, v42
    v_and_b32 v43, 3, v0
    v_lshl_add_u32 v42, v43, 3, v42
    v_add_u32 v42, s59, v42
    s_mov_b32 s33, 73728
    v_mul_lo_u32 v55, v41, s33
    v_mul_u32_u24 v43, 1152, v43
    v_add_u32 v55, v55, v43
    v_lshl_add_u32 v55, v40, 4, v55
    v_mul_lo_u32 v56, v40, s33
    v_and_b32 v43, 7, v0
    v_mul_u32_u24 v43, 1152, v43
    v_add_u32 v56, v56, v43
    v_lshlrev_b32 v54, 14, v40
    v_lshlrev_b32 v50, 8, v40
    v_and_b32 v43, 15, v0
    v_lshl_add_u32 v50, v43, 2, v50
    v_lshl_add_u32 v54, v43, 4, v54
    s_lshl_b32 s33, s28, 10
    v_add_u32 v50, s33, v50
    v_mov_b32 v40, 0
    s_mov_b32 s58, 0
L_B_flag:
    ds_read_b32 v41, v40 offset:2032
    s_waitcnt lgkmcnt(0)
    v_readfirstlane_b32 s72, v41
    s_add_u32 s58, s58, 1
    s_cmp_ge_u32 s58, 1600000
    s_cbranch_scc1 L_B_flag_ok
    s_cmp_eq_u32 s72, 512
    s_cbranch_scc1 L_B_flag_ok
    s_sleep 4
    s_branch L_B_flag
L_B_flag_ok:
    s_mov_b32 s33, 0
    buffer_load_dwordx4 v[64:67], v44, s[44:47], s33 offen nt
    s_add_u32 s33, s33, 8192
    buffer_load_dwordx4 v[68:71], v44, s[44:47], s33 offen nt
    s_add_u32 s33, s33, 8192
    buffer_load_dwordx4 v[72:75], v44, s[44:47], s33 offen nt
    s_add_u32 s33, s33, 8192
    buffer_load_dwordx4 v[76:79], v44, s[44:47], s33 offen nt
    s_add_u32 s33, s33, 8192
    buffer_load_dwordx4 v[80:83], v44, s[44:47], s33 offen nt
    s_add_u32 s33, s33, 8192
    buffer_load_dwordx4 v[84:87], v44, s[44:47], s33 offen nt
    s_add_u32 s33, s33, 8192
    buffer_load_dwordx4 v[88:91], v44, s[44:47], s33 offen nt
    s_add_u32 s33, s33, 8192
    buffer_load_dwordx4 v[92:95], v44, s[44:47], s33 offen nt
    s_add_u32 s33, s33, 8192
    buffer_load_dwordx4 v[96:99], v44, s[44:47], s33 offen nt
    s_add_u32 s33, s33, 8192
    buffer_load_dwordx4 v[100:103], v44, s[44:47], s33 offen nt
    s_add_u32 s33, s33, 8192
    buffer_load_dwordx4 v[104:107], v44, s[44:47], s33 offen nt
    s_add_u32 s33, s33, 8192
    buffer_load_dwordx4 v[108:111], v44, s[44:47], s33 offen nt
    s_add_u32 s33, s33, 8192
    buffer_load_dwordx4 v[112:115], v44, s[44:47], s33 offen nt
    s_add_u32 s33, s33, 8192
    buffer_load_dwordx4 v[116:119], v44, s[44:47], s33 offen nt
    s_add_u32 s33, s33, 8192
    buffer_load_dwordx4 v[120:123], v44, s[44:47], s33 offen nt
    s_add_u32 s33, s33, 8192
    buffer_load_dwordx4 v[124:127], v44, s[44:47], s33 offen nt
    s_mul_i32 s33, s29, 9216
    s_lshl_b32 s35, s28, 2
    s_add_u32 s35, s35, s33
    s_lshl_b32 s34, s28, 8
    s_add_u32 s33, s33, s34
    s_add_u32 s34, s33, 4608
    s_lshl_b32 s59, s29, 11
    s_lshl_b32 s55, s32, 8
    s_add_u32 s59, s59, s55
    s_add_u32 s59, s59, 327680
    s_waitcnt vmcnt(12)
    ds_write_b128 v45, v[64:67] offset:0
    ds_write_b128 v45, v[68:71] offset:1024
    ds_write_b128 v45, v[72:75] offset:2048
    ds_write_b128 v45, v[76:79] offset:3072
    s_waitcnt vmcnt(8)
    ds_write_b128 v45, v[80:83] offset:4096
    ds_write_b128 v45, v[84:87] offset:5120
    ds_write_b128 v45, v[88:91] offset:6144
    ds_write_b128 v45, v[92:95] offset:7168
    s_waitcnt vmcnt(4)
    ds_write_b128 v45, v[96:99] offset:8192
    ds_write_b128 v45, v[100:103] offset:9216
    ds_write_b128 v45, v[104:107] offset:10240
    ds_write_b128 v45, v[108:111] offset:11264
    s_waitcnt vmcnt(0)
    ds_write_b128 v45, v[112:115] offset:12288
    ds_write_b128 v45, v[116:119] offset:13312
    ds_write_b128 v45, v[120:123] offset:14336
    ds_write_b128 v45, v[124:127] offset:15360
    s_waitcnt lgkmcnt(0)
    ds_read_b64_tr_b16 v[128:129], v42 offset:0
    ds_read_b64_tr_b16 v[130:131], v42 offset:512
    ds_read_b64_tr_b16 v[132:133], v42 offset:32
    ds_read_b64_tr_b16 v[134:135], v42 offset:544
    ds_read_b64_tr_b16 v[136:137], v42 offset:64
    ds_read_b64_tr_b16 v[138:139], v42 offset:576
    ds_read_b64_tr_b16 v[140:141], v42 offset:96
    ds_read_b64_tr_b16 v[142:143], v42 offset:608
    ds_read_b64_tr_b16 v[144:145], v42 offset:4096
    ds_read_b64_tr_b16 v[146:147], v42 offset:4608
    ds_read_b64_tr_b16 v[148:149], v42 offset:4128
    ds_read_b64_tr_b16 v[150:151], v42 offset:4640
    ds_read_b64_tr_b16 v[152:153], v42 offset:4160
    ds_read_b64_tr_b16 v[154:155], v42 offset:4672
    ds_read_b64_tr_b16 v[156:157], v42 offset:4192
    ds_read_b64_tr_b16 v[158:159], v42 offset:4704
    ds_read_b64_tr_b16 v[160:161], v42 offset:8192
    ds_read_b64_tr_b16 v[162:163], v42 offset:8704
    ds_read_b64_tr_b16 v[164:165], v42 offset:8224
    ds_read_b64_tr_b16 v[166:167], v42 offset:8736
    ds_read_b64_tr_b16 v[168:169], v42 offset:8256
    ds_read_b64_tr_b16 v[170:171], v42 offset:8768
    ds_read_b64_tr_b16 v[172:173], v42 offset:8288
    ds_read_b64_tr_b16 v[174:175], v42 offset:8800
    ds_read_b64_tr_b16 v[176:177], v42 offset:12288
    ds_read_b64_tr_b16 v[178:179], v42 offset:12800
    ds_read_b64_tr_b16 v[180:181], v42 offset:12320
    ds_read_b64_tr_b16 v[182:183], v42 offset:12832
    ds_read_b64_tr_b16 v[184:185], v42 offset:12352
    ds_read_b64_tr_b16 v[186:187], v42 offset:12864
    ds_read_b64_tr_b16 v[188:189], v42 offset:12384
    ds_read_b64_tr_b16 v[190:191], v42 offset:12896
    s_mov_b32 s58, 0
    v_mov_b32 v40, 0
    s_mov_b32 s58, 0
L_B_f2:
    ds_read_b32 v41, v40 offset:2044
    s_waitcnt lgkmcnt(0)
    v_readfirstlane_b32 s72, v41
    s_add_u32 s58, s58, 1
    s_cmp_ge_u32 s58, 1600000
    s_cbranch_scc1 L_B_f2_ok
    s_cmp_eq_u32 s72, 256
    s_cbranch_scc1 L_B_f2_ok
    s_sleep 2
    s_branch L_B_f2
L_B_f2_ok:
    s_mov_b32 s58, 0
    s_mov_b64 s[64:65], -1
    s_mov_b64 s[66:67], -1
    s_mov_b64 s[68:69], -1
L_B_poll:
    s_mov_b64 exec, s[64:65]
    s_cbranch_execz L_B_sk0
    buffer_load_dwordx4 v[64:67], v55, s[48:51], s33 offen offset:0 sc1
    buffer_load_dwordx4 v[68:71], v55, s[48:51], s33 offen offset:64 sc1
    buffer_load_dwordx4 v[72:75], v55, s[48:51], s33 offen offset:128 sc1
    buffer_load_dwordx4 v[76:79], v55, s[48:51], s33 offen offset:192 sc1
L_B_sk0:
    s_mov_b64 exec, s[66:67]
    s_cbranch_execz L_B_sk1
    buffer_load_dwordx4 v[80:83], v55, s[48:51], s34 offen offset:0 sc1
    buffer_load_dwordx4 v[84:87], v55, s[48:51], s34 offen offset:64 sc1
    buffer_load_dwordx4 v[88:91], v55, s[48:51], s34 offen offset:128 sc1
    buffer_load_dwordx4 v[92:95], v55, s[48:51], s34 offen offset:192 sc1
L_B_sk1:
    s_mov_b64 exec, s[68:69]
    s_cbranch_execz L_B_sk2
    buffer_load_dword v52, v56, s[48:51], s35 offen offset:1024 sc1
L_B_sk2:
    s_mov_b64 exec, -1
    s_waitcnt vmcnt(0)
    v_max3_u32 v42, v64, v65, v66
    v_max3_u32 v42, v42, v67, v68
    v_max3_u32 v42, v42, v69, v70
    v_max3_u32 v42, v42, v71, v72
    v_max3_u32 v42, v42, v73, v74
    v_max3_u32 v42, v42, v75, v76
    v_max3_u32 v42, v42, v77, v78
    v_max_u32 v42, v42, v79
    v_max3_u32 v43, v80, v81, v82
    v_max3_u32 v43, v43, v83, v84
    v_max3_u32 v43, v43, v85, v86
    v_max3_u32 v43, v43, v87, v88
    v_max3_u32 v43, v43, v89, v90
    v_max3_u32 v43, v43, v91, v92
    v_max3_u32 v43, v43, v93, v94
    v_max_u32 v43, v43, v95
    v_cmp_eq_u32 s[68:69], -1, v52
    v_cmp_eq_u32 s[64:65], -1, v42
    v_cmp_eq_u32 s[66:67], -1, v43
    s_nop 0
    s_or_b64 s[72:73], s[64:65], s[66:67]
    s_add_u32 s58, s58, 1
    s_cmp_ge_u32 s58, 200000
    s_cbranch_scc1 L_B_go
    s_or_b64 s[72:73], s[72:73], s[68:69]
    s_cbranch_scc1 L_B_poll
L_B_go:
    v_mfma_f32_16x16x32_bf16 v[192:195], v[64:67], v[128:131], 0
    v_mfma_f32_16x16x32_bf16 v[192:195], v[68:71], v[144:147], v[192:195]
    v_mfma_f32_16x16x32_bf16 v[192:195], v[72:75], v[160:163], v[192:195]
    v_mfma_f32_16x16x32_bf16 v[192:195], v[76:79], v[176:179], v[192:195]
    v_mov_b32 v57, v52
    s_nop 1
    v_max_f32_dpp v57, v57, v57 quad_perm:[1,0,3,2] row_mask:0xf bank_mask:0xf
    s_nop 1
    v_max_f32_dpp v57, v57, v57 quad_perm:[2,3,0,1] row_mask:0xf bank_mask:0xf
    s_nop 1
    v_max_f32_dpp v57, v57, v57 row_half_mirror row_mask:0xf bank_mask:0xf
    v_mfma_f32_16x16x32_bf16 v[196:199], v[64:67], v[132:135], 0
    v_mfma_f32_16x16x32_bf16 v[196:199], v[68:71], v[148:151], v[196:199]
    v_mfma_f32_16x16x32_bf16 v[196:199], v[72:75], v[164:167], v[196:199]
    v_mfma_f32_16x16x32_bf16 v[196:199], v[76:79], v[180:183], v[196:199]
    v_sub_f32 v57, v52, v57
    v_exp_f32 v57, v57
    v_mfma_f32_16x16x32_bf16 v[200:203], v[64:67], v[136:139], 0
    v_mfma_f32_16x16x32_bf16 v[200:203], v[68:71], v[152:155], v[200:203]
    v_mfma_f32_16x16x32_bf16 v[200:203], v[72:75], v[168:171], v[200:203]
    v_mfma_f32_16x16x32_bf16 v[200:203], v[76:79], v[184:187], v[200:203]
    v_mov_b32 v41, v57
    s_nop 1
    v_add_f32_dpp v41, v41, v41 quad_perm:[1,0,3,2] row_mask:0xf bank_mask:0xf
    s_nop 1
    v_add_f32_dpp v41, v41, v41 quad_perm:[2,3,0,1] row_mask:0xf bank_mask:0xf
    s_nop 1
    v_add_f32_dpp v41, v41, v41 row_half_mirror row_mask:0xf bank_mask:0xf
    v_mfma_f32_16x16x32_bf16 v[204:207], v[64:67], v[140:143], 0
    v_mfma_f32_16x16x32_bf16 v[204:207], v[68:71], v[156:159], v[204:207]
    v_mfma_f32_16x16x32_bf16 v[204:207], v[72:75], v[172:175], v[204:207]
    v_mfma_f32_16x16x32_bf16 v[204:207], v[76:79], v[188:191], v[204:207]
    v_rcp_f32 v41, v41
    s_nop 0
    v_mul_f32 v57, v57, v41
    v_mfma_f32_16x16x32_bf16 v[208:211], v[80:83], v[128:131], 0
    v_mfma_f32_16x16x32_bf16 v[208:211], v[84:87], v[144:147], v[208:211]
    v_mfma_f32_16x16x32_bf16 v[208:211], v[88:91], v[160:163], v[208:211]
    v_mfma_f32_16x16x32_bf16 v[208:211], v[92:95], v[176:179], v[208:211]
    v_mfma_f32_16x16x32_bf16 v[212:215], v[80:83], v[132:135], 0
    v_mfma_f32_16x16x32_bf16 v[212:215], v[84:87], v[148:151], v[212:215]
    v_mfma_f32_16x16x32_bf16 v[212:215], v[88:91], v[164:167], v[212:215]
    v_mfma_f32_16x16x32_bf16 v[212:215], v[92:95], v[180:183], v[212:215]
    v_mul_f32_dpp v58, v57, v192 row_newbcast:0 row_mask:0xf bank_mask:0xf
    s_nop 1
    v_fmac_f32_dpp v58, v57, v193 row_newbcast:1 row_mask:0xf bank_mask:0xf
    s_nop 1
    v_fmac_f32_dpp v58, v57, v194 row_newbcast:2 row_mask:0xf bank_mask:0xf
    s_nop 1
    v_fmac_f32_dpp v58, v57, v195 row_newbcast:3 row_mask:0xf bank_mask:0xf
    v_mfma_f32_16x16x32_bf16 v[216:219], v[80:83], v[136:139], 0
    v_mfma_f32_16x16x32_bf16 v[216:219], v[84:87], v[152:155], v[216:219]
    v_mfma_f32_16x16x32_bf16 v[216:219], v[88:91], v[168:171], v[216:219]
    v_mfma_f32_16x16x32_bf16 v[216:219], v[92:95], v[184:187], v[216:219]
    v_mul_f32_dpp v59, v57, v196 row_newbcast:0 row_mask:0xf bank_mask:0xf
    s_nop 1
    v_fmac_f32_dpp v59, v57, v197 row_newbcast:1 row_mask:0xf bank_mask:0xf
    s_nop 1
    v_fmac_f32_dpp v59, v57, v198 row_newbcast:2 row_mask:0xf bank_mask:0xf
    s_nop 1
    v_fmac_f32_dpp v59, v57, v199 row_newbcast:3 row_mask:0xf bank_mask:0xf
    v_mfma_f32_16x16x32_bf16 v[220:223], v[80:83], v[140:143], 0
    v_mfma_f32_16x16x32_bf16 v[220:223], v[84:87], v[156:159], v[220:223]
    v_mfma_f32_16x16x32_bf16 v[220:223], v[88:91], v[172:175], v[220:223]
    v_mfma_f32_16x16x32_bf16 v[220:223], v[92:95], v[188:191], v[220:223]
    v_mul_f32_dpp v60, v57, v200 row_newbcast:0 row_mask:0xf bank_mask:0xf
    s_nop 1
    v_fmac_f32_dpp v60, v57, v201 row_newbcast:1 row_mask:0xf bank_mask:0xf
    s_nop 1
    v_fmac_f32_dpp v60, v57, v202 row_newbcast:2 row_mask:0xf bank_mask:0xf
    s_nop 1
    v_fmac_f32_dpp v60, v57, v203 row_newbcast:3 row_mask:0xf bank_mask:0xf
    v_mul_f32_dpp v61, v57, v204 row_newbcast:0 row_mask:0xf bank_mask:0xf
    s_nop 1
    v_fmac_f32_dpp v61, v57, v205 row_newbcast:1 row_mask:0xf bank_mask:0xf
    s_nop 1
    v_fmac_f32_dpp v61, v57, v206 row_newbcast:2 row_mask:0xf bank_mask:0xf
    s_nop 1
    v_fmac_f32_dpp v61, v57, v207 row_newbcast:3 row_mask:0xf bank_mask:0xf
    v_fmac_f32_dpp v58, v57, v208 row_newbcast:4 row_mask:0xf bank_mask:0xf
    s_nop 1
    v_fmac_f32_dpp v58, v57, v209 row_newbcast:5 row_mask:0xf bank_mask:0xf
    s_nop 1
    v_fmac_f32_dpp v58, v57, v210 row_newbcast:6 row_mask:0xf bank_mask:0xf
    s_nop 1
    v_fmac_f32_dpp v58, v57, v211 row_newbcast:7 row_mask:0xf bank_mask:0xf
    ds_write_b32 v50, v58 offset:23552
    v_fmac_f32_dpp v59, v57, v212 row_newbcast:4 row_mask:0xf bank_mask:0xf
    s_nop 1
    v_fmac_f32_dpp v59, v57, v213 row_newbcast:5 row_mask:0xf bank_mask:0xf
    s_nop 1
    v_fmac_f32_dpp v59, v57, v214 row_newbcast:6 row_mask:0xf bank_mask:0xf
    s_nop 1
    v_fmac_f32_dpp v59, v57, v215 row_newbcast:7 row_mask:0xf bank_mask:0xf
    ds_write_b32 v50, v59 offset:23616
    v_fmac_f32_dpp v60, v57, v216 row_newbcast:4 row_mask:0xf bank_mask:0xf
    s_nop 1
    v_fmac_f32_dpp v60, v57, v217 row_newbcast:5 row_mask:0xf bank_mask:0xf
    s_nop 1
    v_fmac_f32_dpp v60, v57, v218 row_newbcast:6 row_mask:0xf bank_mask:0xf
    s_nop 1
    v_fmac_f32_dpp v60, v57, v219 row_newbcast:7 row_mask:0xf bank_mask:0xf
    ds_write_b32 v50, v60 offset:23680
    v_fmac_f32_dpp v61, v57, v220 row_newbcast:4 row_mask:0xf bank_mask:0xf
    s_nop 1
    v_fmac_f32_dpp v61, v57, v221 row_newbcast:5 row_mask:0xf bank_mask:0xf
    s_nop 1
    v_fmac_f32_dpp v61, v57, v222 row_newbcast:6 row_mask:0xf bank_mask:0xf
    s_nop 1
    v_fmac_f32_dpp v61, v57, v223 row_newbcast:7 row_mask:0xf bank_mask:0xf
    ds_write_b32 v50, v61 offset:23744
    s_waitcnt lgkmcnt(0)
    s_barrier
    s_cmp_lg_u32 s28, 0
    s_cbranch_scc1 L_end
    ds_read_b128 v[224:227], v51 offset:23552
    ds_read_b128 v[228:231], v51 offset:24576
    ds_read_b128 v[232:235], v51 offset:25600
    ds_read_b128 v[236:239], v51 offset:26624
    s_waitcnt lgkmcnt(2)
    v_pk_add_f32 v[224:225], v[224:225], v[228:229]
    v_pk_add_f32 v[226:227], v[226:227], v[230:231]
    s_waitcnt lgkmcnt(0)
    v_pk_add_f32 v[232:233], v[232:233], v[236:237]
    v_pk_add_f32 v[234:235], v[234:235], v[238:239]
    v_pk_add_f32 v[224:225], v[224:225], v[232:233]
    v_pk_add_f32 v[226:227], v[226:227], v[234:235]
    buffer_store_dwordx4 v[224:227], v54, s[48:51], s59 offen sc1
    s_endpgm
L_roleC:
    s_lshl_b32 s33, s28, 10
    s_add_u32 s44, s4, s33
    s_addc_u32 s45, s5, 0
    s_mov_b32 s46, 0x400
    s_mov_b32 s47, 0x20000
    v_lshlrev_b32 v42, 3, v0
    buffer_load_dwordx2 v[48:49], v42, s[44:47], 0 offen
    buffer_load_dwordx2 v[50:51], v42, s[44:47], 0 offen offset:512
    s_mov_b32 s58, 0
    v_mov_b32 v40, 0
L_cntC:
    global_load_dword v41, v40, s[24:25] sc1
    s_waitcnt vmcnt(0)
    v_readfirstlane_b32 s72, v41
    s_add_u32 s58, s58, 1
    s_cmp_ge_u32 s58, 200000
    s_cbranch_scc1 L_cntC_ok
    s_cmp_ge_u32 s72, 256
    s_cbranch_scc1 L_cntC_ok
    s_sleep 32
    s_branch L_cntC
L_cntC_ok:
    v_lshlrev_b32 v52, 16, v48
    v_and_b32 v53, 0xffff0000, v48
    v_lshlrev_b32 v54, 16, v49
    v_and_b32 v55, 0xffff0000, v49
    v_lshlrev_b32 v56, 16, v50
    v_and_b32 v57, 0xffff0000, v50
    v_lshlrev_b32 v58, 16, v51
    v_and_b32 v59, 0xffff0000, v51
    s_lshl_b32 s33, s60, 6
    s_sub_u32 s34, 1835008, s33
    s_add_u32 s44, s16, s33
    s_addc_u32 s45, s17, 0
    s_mov_b32 s46, s34
    s_mov_b32 s47, 0x20000
    s_add_u32 s64, s18, s33
    s_addc_u32 s65, s19, 0
    s_mov_b32 s66, s34
    s_mov_b32 s67, 0x20000
    s_lshl_b32 s33, s60, 15
    s_lshl_b32 s34, s28, 8
    s_add_u32 s33, s33, s34
    s_add_u32 s68, s20, s33
    s_addc_u32 s69, s21, 0
    s_mov_b32 s70, 0x7d00
    s_mov_b32 s71, 0x20000
    v_lshrrev_b32 v8, 2, v0
    v_mul_u32_u24 v8, 3584, v8
    v_and_b32 v40, 3, v0
    v_lshl_add_u32 v8, v40, 4, v8
    v_lshrrev_b32 v43, 4, v0
    v_lshlrev_b32 v9, 10, v43
    v_and_b32 v41, 15, v0
    v_lshl_add_u32 v9, v41, 4, v9
    v_bfe_u32 v41, v0, 2, 2
    v_lshl_add_u32 v42, v43, 3, v41
    v_lshlrev_b32 v11, 8, v42
    v_lshlrev_b32 v10, 6, v42
    v_and_b32 v41, 1, v0
    v_lshl_add_u32 v10, v41, 3, v10
    v_bfe_u32 v41, v0, 1, 1
    v_lshl_add_u32 v10, v41, 15, v10
    s_lshl_b32 s33, s28, 4
    s_add_u32 s33, s33, 32768
    v_add_u32 v10, s33, v10
    v_lshl_add_u32 v11, v40, 3, v11
    s_lshl_b32 s33, s28, 13
    s_add_u32 s34, s33, 32768
    s_add_u32 s33, s33, 98304
    v_add_u32 v11, s33, v11
    v_lshlrev_b32 v12, 4, v0
    v_add_u32 v18, s34, v12
    v_lshlrev_b32 v13, 3, v0
    s_mul_i32 s33, s28, 1056
    v_add_u32 v13, s33, v13
    v_mul_u32_u24 v14, 1056, v40
    v_lshl_add_u32 v14, v43, 4, v14
    v_lshlrev_b32 v15, 1, v0
    s_lshl_b32 s33, s28, 4
    v_add_u32 v15, s33, v15
    v_lshlrev_b32 v17, 11, v40
    v_lshlrev_b32 v16, 6, v40
    v_lshl_add_u32 v16, v43, 4, v16
    v_lshl_add_u32 v17, v43, 4, v17
    s_lshl_b32 s59, s60, 13
    s_lshl_b32 s34, s28, 9
    s_add_u32 s59, s59, s34
    s_add_u32 s59, s59, 393216
    s_mul_i32 s33, s28, 458752
    v_mov_b32 v40, 0
    s_mov_b32 s58, 0
L_C_f2:
    ds_read_b32 v41, v40 offset:2032
    s_waitcnt lgkmcnt(0)
    v_readfirstlane_b32 s72, v41
    s_add_u32 s58, s58, 1
    s_cmp_ge_u32 s58, 1600000
    s_cbranch_scc1 L_C_f2_ok
    s_cmp_eq_u32 s72, 512
    s_cbranch_scc1 L_C_f2_ok
    s_sleep 4
    s_branch L_C_f2
L_C_f2_ok:
    s_mov_b32 s35, s33
    buffer_load_dwordx4 v[128:131], v8, s[44:47], s35 offen nt
    s_add_u32 s35, s35, 57344
    buffer_load_dwordx4 v[132:135], v8, s[44:47], s35 offen nt
    s_add_u32 s35, s35, 57344
    buffer_load_dwordx4 v[136:139], v8, s[44:47], s35 offen nt
    s_add_u32 s35, s35, 57344
    buffer_load_dwordx4 v[140:143], v8, s[44:47], s35 offen nt
    s_add_u32 s35, s35, 57344
    buffer_load_dwordx4 v[144:147], v8, s[44:47], s35 offen nt
    s_add_u32 s35, s35, 57344
    buffer_load_dwordx4 v[148:151], v8, s[44:47], s35 offen nt
    s_add_u32 s35, s35, 57344
    buffer_load_dwordx4 v[152:155], v8, s[44:47], s35 offen nt
    s_add_u32 s35, s35, 57344
    buffer_load_dwordx4 v[156:159], v8, s[44:47], s35 offen nt
    s_mov_b32 s35, s33
    buffer_load_dwordx4 v[160:163], v8, s[64:67], s35 offen nt
    s_add_u32 s35, s35, 57344
    buffer_load_dwordx4 v[164:167], v8, s[64:67], s35 offen nt
    s_add_u32 s35, s35, 57344
    buffer_load_dwordx4 v[168:171], v8, s[64:67], s35 offen nt
    s_add_u32 s35, s35, 57344
    buffer_load_dwordx4 v[172:175], v8, s[64:67], s35 offen nt
    s_add_u32 s35, s35, 57344
    buffer_load_dwordx4 v[176:179], v8, s[64:67], s35 offen nt
    s_add_u32 s35, s35, 57344
    buffer_load_dwordx4 v[180:183], v8, s[64:67], s35 offen nt
    s_add_u32 s35, s35, 57344
    buffer_load_dwordx4 v[184:187], v8, s[64:67], s35 offen nt
    s_add_u32 s35, s35, 57344
    buffer_load_dwordx4 v[188:191], v8, s[64:67], s35 offen nt
    s_mov_b32 s35, 0
    buffer_load_dwordx4 v[192:195], v9, s[68:71], s35 offen nt
    s_add_u32 s35, s35, 4096
    buffer_load_dwordx4 v[196:199], v9, s[68:71], s35 offen nt
    s_add_u32 s35, s35, 4096
    buffer_load_dwordx4 v[200:203], v9, s[68:71], s35 offen nt
    s_add_u32 s35, s35, 4096
    buffer_load_dwordx4 v[204:207], v9, s[68:71], s35 offen nt
    s_add_u32 s35, s35, 4096
    buffer_load_dwordx4 v[208:211], v9, s[68:71], s35 offen nt
    s_add_u32 s35, s35, 4096
    buffer_load_dwordx4 v[212:215], v9, s[68:71], s35 offen nt
    s_add_u32 s35, s35, 4096
    buffer_load_dwordx4 v[216:219], v9, s[68:71], s35 offen nt
    s_add_u32 s35, s35, 4096
    buffer_load_dwordx4 v[220:223], v9, s[68:71], s35 offen nt
    v_add_u32 v41, 0x8000, v18
    v_add_u32 v42, 0x10000, v18
    s_lshl_b32 s33, s28, 14
    s_add_u32 s33, s33, 327680
    s_add_u32 s34, s33, 4096
    s_add_u32 s35, s33, 8192
    s_add_u32 s60, s33, 12288
    s_waitcnt vmcnt(20)
    ds_write_b128 v18, v[128:131] offset:0
    ds_write_b128 v18, v[132:135] offset:1024
    ds_write_b128 v18, v[136:139] offset:2048
    ds_write_b128 v18, v[140:143] offset:3072
    s_waitcnt vmcnt(16)
    ds_write_b128 v18, v[144:147] offset:4096
    ds_write_b128 v18, v[148:151] offset:5120
    ds_write_b128 v18, v[152:155] offset:6144
    ds_write_b128 v18, v[156:159] offset:7168
    s_waitcnt vmcnt(12)
    ds_write_b128 v41, v[160:163] offset:0
    ds_write_b128 v41, v[164:167] offset:1024
    ds_write_b128 v41, v[168:171] offset:2048
    ds_write_b128 v41, v[172:175] offset:3072
    s_waitcnt vmcnt(8)
    ds_write_b128 v41, v[176:179] offset:4096
    ds_write_b128 v41, v[180:183] offset:5120
    ds_write_b128 v41, v[184:187] offset:6144
    ds_write_b128 v41, v[188:191] offset:7168
    s_waitcnt vmcnt(4)
    ds_write_b128 v42, v[192:195] offset:0
    ds_write_b128 v42, v[196:199] offset:1024
    ds_write_b128 v42, v[200:203] offset:2048
    ds_write_b128 v42, v[204:207] offset:3072
    s_waitcnt vmcnt(0)
    ds_write_b128 v42, v[208:211] offset:4096
    ds_write_b128 v42, v[212:215] offset:5120
    ds_write_b128 v42, v[216:219] offset:6144
    ds_write_b128 v42, v[220:223] offset:7168
    s_mov_b32 s58, 0
    s_waitcnt lgkmcnt(0)
    s_barrier
    s_mov_b32 s73, 0
    buffer_load_dwordx4 v[64:67], v12, s[48:51], s33 offen offset:0 sc1
    buffer_load_dwordx4 v[68:71], v12, s[48:51], s33 offen offset:1024 sc1
    buffer_load_dwordx4 v[72:75], v12, s[48:51], s33 offen offset:2048 sc1
    buffer_load_dwordx4 v[76:79], v12, s[48:51], s33 offen offset:3072 sc1
    buffer_load_dwordx4 v[80:83], v12, s[48:51], s34 offen offset:0 sc1
    buffer_load_dwordx4 v[84:87], v12, s[48:51], s34 offen offset:1024 sc1
    buffer_load_dwordx4 v[88:91], v12, s[48:51], s34 offen offset:2048 sc1
    buffer_load_dwordx4 v[92:95], v12, s[48:51], s34 offen offset:3072 sc1
    buffer_load_dwordx4 v[96:99], v12, s[48:51], s35 offen offset:0 sc1
    buffer_load_dwordx4 v[100:103], v12, s[48:51], s35 offen offset:1024 sc1
    buffer_load_dwordx4 v[104:107], v12, s[48:51], s35 offen offset:2048 sc1
    buffer_load_dwordx4 v[108:111], v12, s[48:51], s35 offen offset:3072 sc1
    buffer_load_dwordx4 v[112:115], v12, s[48:51], s60 offen offset:0 sc1
    buffer_load_dwordx4 v[116:119], v12, s[48:51], s60 offen offset:1024 sc1
    buffer_load_dwordx4 v[120:123], v12, s[48:51], s60 offen offset:2048 sc1
    buffer_load_dwordx4 v[124:127], v12, s[48:51], s60 offen offset:3072 sc1
    ds_read_b64_tr_b16 v[128:129], v10 offset:0
    ds_read_b64_tr_b16 v[130:131], v10 offset:256
    ds_read_b64_tr_b16 v[132:133], v10 offset:2048
    ds_read_b64_tr_b16 v[134:135], v10 offset:2304
    ds_read_b64_tr_b16 v[136:137], v10 offset:4096
    ds_read_b64_tr_b16 v[138:139], v10 offset:4352
    ds_read_b64_tr_b16 v[140:141], v10 offset:6144
    ds_read_b64_tr_b16 v[142:143], v10 offset:6400
    ds_read_b64_tr_b16 v[144:145], v10 offset:8192
    ds_read_b64_tr_b16 v[146:147], v10 offset:8448
    ds_read_b64_tr_b16 v[148:149], v10 offset:10240
    ds_read_b64_tr_b16 v[150:151], v10 offset:10496
    ds_read_b64_tr_b16 v[152:153], v10 offset:12288
    ds_read_b64_tr_b16 v[154:155], v10 offset:12544
    ds_read_b64_tr_b16 v[156:157], v10 offset:14336
    ds_read_b64_tr_b16 v[158:159], v10 offset:14592
    ds_read_b64_tr_b16 v[160:161], v10 offset:16384
    ds_read_b64_tr_b16 v[162:163], v10 offset:16640
    ds_read_b64_tr_b16 v[164:165], v10 offset:18432
    ds_read_b64_tr_b16 v[166:167], v10 offset:18688
    ds_read_b64_tr_b16 v[168:169], v10 offset:20480
    ds_read_b64_tr_b16 v[170:171], v10 offset:20736
    ds_read_b64_tr_b16 v[172:173], v10 offset:22528
    ds_read_b64_tr_b16 v[174:175], v10 offset:22784
    ds_read_b64_tr_b16 v[176:177], v10 offset:24576
    ds_read_b64_tr_b16 v[178:179], v10 offset:24832
    ds_read_b64_tr_b16 v[180:181], v10 offset:26624
    ds_read_b64_tr_b16 v[182:183], v10 offset:26880
    ds_read_b64_tr_b16 v[184:185], v10 offset:28672
    ds_read_b64_tr_b16 v[186:187], v10 offset:28928
    ds_read_b64_tr_b16 v[188:189], v10 offset:30720
    ds_read_b64_tr_b16 v[190:191], v10 offset:30976
    ds_read_b64_tr_b16 v[192:193], v11 offset:0
    ds_read_b64_tr_b16 v[194:195], v11 offset:1024
    ds_read_b64_tr_b16 v[196:197], v11 offset:32
    ds_read_b64_tr_b16 v[198:199], v11 offset:1056
    ds_read_b64_tr_b16 v[200:201], v11 offset:64
    ds_read_b64_tr_b16 v[202:203], v11 offset:1088
    ds_read_b64_tr_b16 v[204:205], v11 offset:96
    ds_read_b64_tr_b16 v[206:207], v11 offset:1120
    ds_read_b64_tr_b16 v[208:209], v11 offset:128
    ds_read_b64_tr_b16 v[210:211], v11 offset:1152
    ds_read_b64_tr_b16 v[212:213], v11 offset:160
    ds_read_b64_tr_b16 v[214:215], v11 offset:1184
    ds_read_b64_tr_b16 v[216:217], v11 offset:192
    ds_read_b64_tr_b16 v[218:219], v11 offset:1216
    ds_read_b64_tr_b16 v[220:221], v11 offset:224
    ds_read_b64_tr_b16 v[222:223], v11 offset:1248
    s_branch L_C_chk
L_C_poll:
    s_bitcmp1_b32 s73, 0
    s_cbranch_scc1 L_C_ls0
    buffer_load_dwordx4 v[64:67], v12, s[48:51], s33 offen offset:0 sc1
    buffer_load_dwordx4 v[68:71], v12, s[48:51], s33 offen offset:1024 sc1
L_C_ls0:
    s_bitcmp1_b32 s73, 1
    s_cbranch_scc1 L_C_ls1
    buffer_load_dwordx4 v[72:75], v12, s[48:51], s33 offen offset:2048 sc1
    buffer_load_dwordx4 v[76:79], v12, s[48:51], s33 offen offset:3072 sc1
L_C_ls1:
    s_bitcmp1_b32 s73, 2
    s_cbranch_scc1 L_C_ls2
    buffer_load_dwordx4 v[80:83], v12, s[48:51], s34 offen offset:0 sc1
    buffer_load_dwordx4 v[84:87], v12, s[48:51], s34 offen offset:1024 sc1
L_C_ls2:
    s_bitcmp1_b32 s73, 3
    s_cbranch_scc1 L_C_ls3
    buffer_load_dwordx4 v[88:91], v12, s[48:51], s34 offen offset:2048 sc1
    buffer_load_dwordx4 v[92:95], v12, s[48:51], s34 offen offset:3072 sc1
L_C_ls3:
    s_bitcmp1_b32 s73, 4
    s_cbranch_scc1 L_C_ls4
    buffer_load_dwordx4 v[96:99], v12, s[48:51], s35 offen offset:0 sc1
    buffer_load_dwordx4 v[100:103], v12, s[48:51], s35 offen offset:1024 sc1
L_C_ls4:
    s_bitcmp1_b32 s73, 5
    s_cbranch_scc1 L_C_ls5
    buffer_load_dwordx4 v[104:107], v12, s[48:51], s35 offen offset:2048 sc1
    buffer_load_dwordx4 v[108:111], v12, s[48:51], s35 offen offset:3072 sc1
L_C_ls5:
    s_bitcmp1_b32 s73, 6
    s_cbranch_scc1 L_C_ls6
    buffer_load_dwordx4 v[112:115], v12, s[48:51], s60 offen offset:0 sc1
    buffer_load_dwordx4 v[116:119], v12, s[48:51], s60 offen offset:1024 sc1
L_C_ls6:
    s_bitcmp1_b32 s73, 7
    s_cbranch_scc1 L_C_ls7
    buffer_load_dwordx4 v[120:123], v12, s[48:51], s60 offen offset:2048 sc1
    buffer_load_dwordx4 v[124:127], v12, s[48:51], s60 offen offset:3072 sc1
L_C_ls7:
L_C_chk:
    s_waitcnt vmcnt(0)
    s_bitcmp1_b32 s73, 0
    s_cbranch_scc1 L_C_cs0
    v_max3_u32 v42, v64, v65, v66
    v_max3_u32 v43, v67, v68, v69
    v_max3_u32 v42, v42, v70, v71
    v_max_u32 v42, v42, v43
    v_cmp_eq_u32 vcc, -1, v42
    s_nop 0
    s_cbranch_vccnz L_C_cs0
    s_bitset1_b32 s73, 0
L_C_cs0:
    s_bitcmp1_b32 s73, 1
    s_cbranch_scc1 L_C_cs1
    v_max3_u32 v42, v72, v73, v74
    v_max3_u32 v43, v75, v76, v77
    v_max3_u32 v42, v42, v78, v79
    v_max_u32 v42, v42, v43
    v_cmp_eq_u32 vcc, -1, v42
    s_nop 0
    s_cbranch_vccnz L_C_cs1
    s_bitset1_b32 s73, 1
L_C_cs1:
    s_bitcmp1_b32 s73, 2
    s_cbranch_scc1 L_C_cs2
    v_max3_u32 v42, v80, v81, v82
    v_max3_u32 v43, v83, v84, v85
    v_max3_u32 v42, v42, v86, v87
    v_max_u32 v42, v42, v43
    v_cmp_eq_u32 vcc, -1, v42
    s_nop 0
    s_cbranch_vccnz L_C_cs2
    s_bitset1_b32 s73, 2
L_C_cs2:
    s_bitcmp1_b32 s73, 3
    s_cbranch_scc1 L_C_cs3
    v_max3_u32 v42, v88, v89, v90
    v_max3_u32 v43, v91, v92, v93
    v_max3_u32 v42, v42, v94, v95
    v_max_u32 v42, v42, v43
    v_cmp_eq_u32 vcc, -1, v42
    s_nop 0
    s_cbranch_vccnz L_C_cs3
    s_bitset1_b32 s73, 3
L_C_cs3:
    s_bitcmp1_b32 s73, 4
    s_cbranch_scc1 L_C_cs4
    v_max3_u32 v42, v96, v97, v98
    v_max3_u32 v43, v99, v100, v101
    v_max3_u32 v42, v42, v102, v103
    v_max_u32 v42, v42, v43
    v_cmp_eq_u32 vcc, -1, v42
    s_nop 0
    s_cbranch_vccnz L_C_cs4
    s_bitset1_b32 s73, 4
L_C_cs4:
    s_bitcmp1_b32 s73, 5
    s_cbranch_scc1 L_C_cs5
    v_max3_u32 v42, v104, v105, v106
    v_max3_u32 v43, v107, v108, v109
    v_max3_u32 v42, v42, v110, v111
    v_max_u32 v42, v42, v43
    v_cmp_eq_u32 vcc, -1, v42
    s_nop 0
    s_cbranch_vccnz L_C_cs5
    s_bitset1_b32 s73, 5
L_C_cs5:
    s_bitcmp1_b32 s73, 6
    s_cbranch_scc1 L_C_cs6
    v_max3_u32 v42, v112, v113, v114
    v_max3_u32 v43, v115, v116, v117
    v_max3_u32 v42, v42, v118, v119
    v_max_u32 v42, v42, v43
    v_cmp_eq_u32 vcc, -1, v42
    s_nop 0
    s_cbranch_vccnz L_C_cs6
    s_bitset1_b32 s73, 6
L_C_cs6:
    s_bitcmp1_b32 s73, 7
    s_cbranch_scc1 L_C_cs7
    v_max3_u32 v42, v120, v121, v122
    v_max3_u32 v43, v123, v124, v125
    v_max3_u32 v42, v42, v126, v127
    v_max_u32 v42, v42, v43
    v_cmp_eq_u32 vcc, -1, v42
    s_nop 0
    s_cbranch_vccnz L_C_cs7
    s_bitset1_b32 s73, 7
L_C_cs7:
    s_add_u32 s58, s58, 1
    s_cmp_ge_u32 s58, 200000
    s_cbranch_scc1 L_C_go
    s_cmp_lg_u32 s73, 0xff
    s_cbranch_scc1 L_C_poll
L_C_go:
    v_pk_add_f32 v[24:25], v[64:65], v[72:73]
    v_pk_add_f32 v[26:27], v[66:67], v[74:75]
    v_pk_add_f32 v[28:29], v[68:69], v[76:77]
    v_pk_add_f32 v[30:31], v[70:71], v[78:79]
    v_pk_add_f32 v[80:81], v[80:81], v[88:89]
    v_pk_add_f32 v[82:83], v[82:83], v[90:91]
    v_pk_add_f32 v[84:85], v[84:85], v[92:93]
    v_pk_add_f32 v[86:87], v[86:87], v[94:95]
    v_pk_add_f32 v[96:97], v[96:97], v[104:105]
    v_pk_add_f32 v[98:99], v[98:99], v[106:107]
    v_pk_add_f32 v[100:101], v[100:101], v[108:109]
    v_pk_add_f32 v[102:103], v[102:103], v[110:111]
    v_pk_add_f32 v[112:113], v[112:113], v[120:121]
    v_pk_add_f32 v[114:115], v[114:115], v[122:123]
    v_pk_add_f32 v[116:117], v[116:117], v[124:125]
    v_pk_add_f32 v[118:119], v[118:119], v[126:127]
    v_pk_add_f32 v[24:25], v[24:25], v[80:81]
    v_pk_add_f32 v[26:27], v[26:27], v[82:83]
    v_pk_add_f32 v[28:29], v[28:29], v[84:85]
    v_pk_add_f32 v[30:31], v[30:31], v[86:87]
    v_pk_add_f32 v[96:97], v[96:97], v[112:113]
    v_pk_add_f32 v[98:99], v[98:99], v[114:115]
    v_pk_add_f32 v[100:101], v[100:101], v[116:117]
    v_pk_add_f32 v[102:103], v[102:103], v[118:119]
    v_pk_add_f32 v[24:25], v[24:25], v[96:97]
    v_pk_add_f32 v[26:27], v[26:27], v[98:99]
    v_pk_add_f32 v[28:29], v[28:29], v[100:101]
    v_pk_add_f32 v[30:31], v[30:31], v[102:103]
    v_cvt_pk_bf16_f32 v42, v24, v25
    v_cvt_pk_bf16_f32 v43, v26, v27
    v_cvt_pk_bf16_f32 v44, v28, v29
    v_cvt_pk_bf16_f32 v45, v30, v31
    v_lshlrev_b32 v64, 16, v42
    v_and_b32 v65, 0xffff0000, v42
    v_lshlrev_b32 v66, 16, v43
    v_and_b32 v67, 0xffff0000, v43
    v_lshlrev_b32 v68, 16, v44
    v_and_b32 v69, 0xffff0000, v44
    v_lshlrev_b32 v70, 16, v45
    v_and_b32 v71, 0xffff0000, v45
    v_pk_add_f32 v[64:65], v[64:65], v[52:53]
    v_pk_add_f32 v[66:67], v[66:67], v[54:55]
    v_pk_add_f32 v[68:69], v[68:69], v[56:57]
    v_pk_add_f32 v[70:71], v[70:71], v[58:59]
    v_cvt_pk_bf16_f32 v42, v64, v65
    v_cvt_pk_bf16_f32 v43, v66, v67
    v_cvt_pk_bf16_f32 v44, v68, v69
    v_cvt_pk_bf16_f32 v45, v70, v71
    v_lshlrev_b32 v64, 16, v42
    v_and_b32 v65, 0xffff0000, v42
    v_lshlrev_b32 v66, 16, v43
    v_and_b32 v67, 0xffff0000, v43
    v_lshlrev_b32 v68, 16, v44
    v_and_b32 v69, 0xffff0000, v44
    v_lshlrev_b32 v70, 16, v45
    v_and_b32 v71, 0xffff0000, v45
    v_readfirstlane_b32 s72, v64
    s_nop 0
    s_mov_b32 s73, s72
    v_pk_add_f32 v[32:33], v[64:65], s[72:73] neg_lo:[0,1] neg_hi:[0,1]
    v_mov_b64 v[20:21], v[32:33]
    v_pk_mul_f32 v[22:23], v[32:33], v[32:33]
    v_pk_add_f32 v[32:33], v[66:67], s[72:73] neg_lo:[0,1] neg_hi:[0,1]
    v_pk_add_f32 v[20:21], v[20:21], v[32:33]
    v_pk_fma_f32 v[22:23], v[32:33], v[32:33], v[22:23]
    v_pk_add_f32 v[32:33], v[68:69], s[72:73] neg_lo:[0,1] neg_hi:[0,1]
    v_pk_add_f32 v[20:21], v[20:21], v[32:33]
    v_pk_fma_f32 v[22:23], v[32:33], v[32:33], v[22:23]
    v_pk_add_f32 v[32:33], v[70:71], s[72:73] neg_lo:[0,1] neg_hi:[0,1]
    v_pk_add_f32 v[20:21], v[20:21], v[32:33]
    v_pk_fma_f32 v[22:23], v[32:33], v[32:33], v[22:23]
    v_add_f32 v20, v20, v21
    v_add_f32 v22, v22, v23
    s_nop 0
    v_add_f32_dpp v20, v20, v20 quad_perm:[1,0,3,2] row_mask:0xf bank_mask:0xf
    v_add_f32_dpp v22, v22, v22 quad_perm:[1,0,3,2] row_mask:0xf bank_mask:0xf
    s_nop 0
    v_add_f32_dpp v20, v20, v20 quad_perm:[2,3,0,1] row_mask:0xf bank_mask:0xf
    v_add_f32_dpp v22, v22, v22 quad_perm:[2,3,0,1] row_mask:0xf bank_mask:0xf
    s_nop 0
    v_add_f32_dpp v20, v20, v20 row_half_mirror row_mask:0xf bank_mask:0xf
    v_add_f32_dpp v22, v22, v22 row_half_mirror row_mask:0xf bank_mask:0xf
    s_nop 0
    v_add_f32_dpp v20, v20, v20 row_mirror row_mask:0xf bank_mask:0xf
    v_add_f32_dpp v22, v22, v22 row_mirror row_mask:0xf bank_mask:0xf
    v_mov_b32 v21, v20
    v_mov_b32 v23, v22
    s_nop 0
    v_permlane16_swap_b32 v20, v21
    v_permlane16_swap_b32 v22, v23
    v_add_f32 v20, v20, v21
    v_add_f32 v22, v22, v23
    v_mov_b32 v21, v20
    v_mov_b32 v23, v22
    s_nop 0
    v_permlane32_swap_b32 v20, v21
    v_permlane32_swap_b32 v22, v23
    v_add_f32 v20, v20, v21
    v_add_f32 v22, v22, v23
    v_mul_f32 v20, 0x3b000000, v20
    v_mul_f32 v22, 0x3b000000, v22
    v_fma_f32 v22, -v20, v20, v22
    v_add_f32 v20, s72, v20
    v_max_f32 v22, 0, v22
    v_cvt_pk_bf16_f32 v22, v22, v22
    v_and_b32 v22, 0xffff0000, v22
    v_cvt_pk_bf16_f32 v20, v20, v20
    v_and_b32 v20, 0xffff0000, v20
    v_add_f32 v22, 0x3727c5ac, v22
    v_sub_f32 v20, 0, v20
    v_cvt_pk_bf16_f32 v22, v22, v22
    v_and_b32 v22, 0xffff0000, v22
    v_mov_b32 v21, v20
    v_sqrt_f32 v22, v22
    v_pk_add_f32 v[64:65], v[64:65], v[20:21]
    v_pk_add_f32 v[66:67], v[66:67], v[20:21]
    v_pk_add_f32 v[68:69], v[68:69], v[20:21]
    v_pk_add_f32 v[70:71], v[70:71], v[20:21]
    v_cvt_pk_bf16_f32 v22, v22, v22
    v_and_b32 v22, 0xffff0000, v22
    v_cvt_pk_bf16_f32 v42, v64, v65
    v_cvt_pk_bf16_f32 v43, v66, v67
    v_cvt_pk_bf16_f32 v44, v68, v69
    v_cvt_pk_bf16_f32 v45, v70, v71
    v_rcp_f32 v22, v22
    v_lshlrev_b32 v64, 16, v42
    v_and_b32 v65, 0xffff0000, v42
    v_lshlrev_b32 v66, 16, v43
    v_and_b32 v67, 0xffff0000, v43
    v_lshlrev_b32 v68, 16, v44
    v_and_b32 v69, 0xffff0000, v44
    v_lshlrev_b32 v70, 16, v45
    v_and_b32 v71, 0xffff0000, v45
    v_mov_b32 v23, v22
    v_pk_mul_f32 v[64:65], v[64:65], v[22:23]
    v_pk_mul_f32 v[66:67], v[66:67], v[22:23]
    v_pk_mul_f32 v[68:69], v[68:69], v[22:23]
    v_pk_mul_f32 v[70:71], v[70:71], v[22:23]
    v_cvt_pk_bf16_f32 v48, v64, v65
    v_cvt_pk_bf16_f32 v49, v66, v67
    v_cvt_pk_bf16_f32 v50, v68, v69
    v_cvt_pk_bf16_f32 v51, v70, v71
    ds_write_b64 v13, v[48:49] offset:18432
    ds_write_b64 v13, v[50:51] offset:18944
    s_waitcnt lgkmcnt(0)
    s_barrier
    ds_read_b128 v[64:67], v14 offset:18432
    ds_read_b128 v[68:71], v14 offset:18496
    ds_read_b128 v[72:75], v14 offset:18560
    ds_read_b128 v[76:79], v14 offset:18624
    ds_read_b128 v[80:83], v14 offset:18688
    ds_read_b128 v[84:87], v14 offset:18752
    ds_read_b128 v[88:91], v14 offset:18816
    ds_read_b128 v[92:95], v14 offset:18880
    ds_read_b128 v[96:99], v14 offset:18944
    ds_read_b128 v[100:103], v14 offset:19008
    ds_read_b128 v[104:107], v14 offset:19072
    ds_read_b128 v[108:111], v14 offset:19136
    ds_read_b128 v[112:115], v14 offset:19200
    ds_read_b128 v[116:119], v14 offset:19264
    ds_read_b128 v[120:123], v14 offset:19328
    ds_read_b128 v[124:127], v14 offset:19392
    s_waitcnt lgkmcnt(12)
    v_mfma_f32_16x16x32_bf16 v[48:51], v[64:67], v[128:131], 0
    v_mfma_f32_16x16x32_bf16 v[224:227], v[68:71], v[132:135], 0
    v_mfma_f32_16x16x32_bf16 v[48:51], v[72:75], v[136:139], v[48:51]
    v_mfma_f32_16x16x32_bf16 v[224:227], v[76:79], v[140:143], v[224:227]
    s_waitcnt lgkmcnt(8)
    v_mfma_f32_16x16x32_bf16 v[48:51], v[80:83], v[144:147], v[48:51]
    v_mfma_f32_16x16x32_bf16 v[224:227], v[84:87], v[148:151], v[224:227]
    v_mfma_f32_16x16x32_bf16 v[48:51], v[88:91], v[152:155], v[48:51]
    v_mfma_f32_16x16x32_bf16 v[224:227], v[92:95], v[156:159], v[224:227]
    s_waitcnt lgkmcnt(4)
    v_mfma_f32_16x16x32_bf16 v[48:51], v[96:99], v[160:163], v[48:51]
    v_mfma_f32_16x16x32_bf16 v[224:227], v[100:103], v[164:167], v[224:227]
    v_mfma_f32_16x16x32_bf16 v[48:51], v[104:107], v[168:171], v[48:51]
    v_mfma_f32_16x16x32_bf16 v[224:227], v[108:111], v[172:175], v[224:227]
    s_waitcnt lgkmcnt(0)
    v_mfma_f32_16x16x32_bf16 v[48:51], v[112:115], v[176:179], v[48:51]
    v_mfma_f32_16x16x32_bf16 v[224:227], v[116:119], v[180:183], v[224:227]
    v_mfma_f32_16x16x32_bf16 v[48:51], v[120:123], v[184:187], v[48:51]
    v_mfma_f32_16x16x32_bf16 v[224:227], v[124:127], v[188:191], v[224:227]
    s_nop 7
    v_pk_add_f32 v[48:49], v[48:49], v[224:225]
    v_pk_add_f32 v[50:51], v[50:51], v[226:227]
    v_cvt_pk_bf16_f32 v42, v48, v49
    v_cvt_pk_bf16_f32 v43, v50, v51
    v_lshlrev_b32 v48, 16, v42
    v_and_b32 v49, 0xffff0000, v42
    v_lshlrev_b32 v50, 16, v43
    v_and_b32 v51, 0xffff0000, v43
    v_mul_f32 v56, s54, v48
    v_mul_f32 v57, s54, v49
    v_mul_f32 v58, s54, v50
    v_mul_f32 v59, s54, v51
    v_exp_f32 v56, v56
    v_exp_f32 v57, v57
    v_exp_f32 v58, v58
    v_exp_f32 v59, v59
    v_mov_b32_dpp v52, v48 row_ror:8 row_mask:0xf bank_mask:0xf
    v_mov_b32_dpp v53, v49 row_ror:8 row_mask:0xf bank_mask:0xf
    v_mov_b32_dpp v54, v50 row_ror:8 row_mask:0xf bank_mask:0xf
    v_mov_b32_dpp v55, v51 row_ror:8 row_mask:0xf bank_mask:0xf
    v_add_f32 v56, 1.0, v56
    v_add_f32 v57, 1.0, v57
    v_add_f32 v58, 1.0, v58
    v_add_f32 v59, 1.0, v59
    v_rcp_f32 v56, v56
    v_rcp_f32 v57, v57
    v_rcp_f32 v58, v58
    v_rcp_f32 v59, v59
    v_pk_mul_f32 v[56:57], v[56:57], v[48:49]
    v_pk_mul_f32 v[58:59], v[58:59], v[50:51]
    v_cvt_pk_bf16_f32 v42, v56, v57
    v_cvt_pk_bf16_f32 v43, v58, v59
    v_lshlrev_b32 v56, 16, v42
    v_and_b32 v57, 0xffff0000, v42
    v_lshlrev_b32 v58, 16, v43
    v_and_b32 v59, 0xffff0000, v43
    v_pk_mul_f32 v[56:57], v[56:57], v[52:53]
    v_pk_mul_f32 v[58:59], v[58:59], v[54:55]
    v_cvt_pk_bf16_f32 v56, v56, v57
    v_cvt_pk_bf16_f32 v58, v58, v59
    s_mov_b32 exec_lo, 0xff
    s_mov_b32 exec_hi, 0x0
    ds_write_b16 v15, v56 offset:23040
    ds_write_b16_d16_hi v15, v56 offset:23104
    ds_write_b16 v15, v58 offset:23168
    ds_write_b16_d16_hi v15, v58 offset:23232
    s_mov_b64 exec, -1
    s_waitcnt lgkmcnt(0)
    s_barrier
    ds_read_b128 v[48:51], v16 offset:23040
    s_waitcnt lgkmcnt(0)
    v_mfma_f32_16x16x32_bf16 v[64:67], v[192:195], v[48:51], 0
    v_mfma_f32_16x16x32_bf16 v[68:71], v[196:199], v[48:51], 0
    v_mfma_f32_16x16x32_bf16 v[72:75], v[200:203], v[48:51], 0
    v_mfma_f32_16x16x32_bf16 v[76:79], v[204:207], v[48:51], 0
    v_mfma_f32_16x16x32_bf16 v[80:83], v[208:211], v[48:51], 0
    v_mfma_f32_16x16x32_bf16 v[84:87], v[212:215], v[48:51], 0
    v_mfma_f32_16x16x32_bf16 v[88:91], v[216:219], v[48:51], 0
    v_mfma_f32_16x16x32_bf16 v[92:95], v[220:223], v[48:51], 0
    s_mov_b32 exec_lo, 0xf000f
    s_mov_b32 exec_hi, 0xf000f
    buffer_store_dwordx4 v[64:67], v17, s[48:51], s59 offen offset:0 sc1
    buffer_store_dwordx4 v[68:71], v17, s[48:51], s59 offen offset:64 sc1
    buffer_store_dwordx4 v[72:75], v17, s[48:51], s59 offen offset:128 sc1
    buffer_store_dwordx4 v[76:79], v17, s[48:51], s59 offen offset:192 sc1
    buffer_store_dwordx4 v[80:83], v17, s[48:51], s59 offen offset:256 sc1
    buffer_store_dwordx4 v[84:87], v17, s[48:51], s59 offen offset:320 sc1
    buffer_store_dwordx4 v[88:91], v17, s[48:51], s59 offen offset:384 sc1
    buffer_store_dwordx4 v[92:95], v17, s[48:51], s59 offen offset:448 sc1
    s_mov_b64 exec, -1
    s_endpgm
L_roleD:
    s_cmp_lg_u32 s28, 0
    s_cbranch_scc1 L_end
    s_lshr_b32 s30, s60, 3
    s_and_b32 s31, s60, 7
    s_lshl_b32 s33, s30, 10
    s_lshl_b32 s34, s31, 7
    s_add_u32 s33, s33, s34
    s_add_u32 s44, s4, s33
    s_addc_u32 s45, s5, 0
    s_mov_b32 s46, 0x80
    s_mov_b32 s47, 0x20000
    s_add_u32 s64, s22, s33
    s_addc_u32 s65, s23, 0
    s_mov_b32 s66, 0x80
    s_mov_b32 s67, 0x20000
    v_and_b32 v41, 15, v0
    v_lshlrev_b32 v46, 3, v41
    buffer_load_dwordx2 v[48:49], v46, s[44:47], 0 offen
    s_add_u32 s68, s26, 1015808
    s_addc_u32 s69, s27, 0
    s_load_dword s62, s[68:69], 0
    s_mov_b32 s58, 0
    v_mov_b32 v40, 0
L_cntD:
    global_load_dword v41, v40, s[24:25] sc1
    s_waitcnt vmcnt(0)
    v_readfirstlane_b32 s72, v41
    s_add_u32 s58, s58, 1
    s_cmp_ge_u32 s58, 200000
    s_cbranch_scc1 L_cntD_ok
    s_cmp_ge_u32 s72, 256
    s_cbranch_scc1 L_cntD_ok
    s_sleep 32
    s_branch L_cntD
L_cntD_ok:
    v_and_b32 v41, 15, v0
    v_lshrrev_b32 v40, 4, v0
    v_lshlrev_b32 v47, 13, v40
    v_lshl_add_u32 v47, v41, 4, v47
    v_lshlrev_b32 v40, 11, v40
    v_lshl_add_u32 v40, v41, 4, v40
    s_lshl_b32 s33, s30, 14
    s_lshl_b32 s34, s31, 8
    s_add_u32 s33, s33, s34
    s_add_u32 s33, s33, 327680
    s_add_u32 s34, s33, 8192
    s_lshl_b32 s35, s30, 11
    s_lshl_b32 s59, s31, 8
    s_add_u32 s35, s35, s59
    s_add_u32 s35, s35, 393216
    v_lshlrev_b32 v52, 16, v48
    v_and_b32 v53, 0xffff0000, v48
    v_lshlrev_b32 v54, 16, v49
    v_and_b32 v55, 0xffff0000, v49
    s_waitcnt lgkmcnt(0)
    v_mov_b32 v48, 0
    s_mov_b32 s58, 0
L_D_f2:
    ds_read_b32 v49, v48 offset:2044
    s_waitcnt lgkmcnt(0)
    v_readfirstlane_b32 s72, v49
    s_add_u32 s58, s58, 1
    s_cmp_ge_u32 s58, 1600000
    s_cbranch_scc1 L_D_f2_ok
    s_cmp_eq_u32 s72, 256
    s_cbranch_scc1 L_D_f2_ok
    s_sleep 8
    s_branch L_D_f2
L_D_f2_ok:
    s_mov_b32 s58, 0
L_D_poll1:
    buffer_load_dwordx4 v[64:67], v40, s[48:51], s33 offen sc1
    buffer_load_dwordx4 v[68:71], v40, s[48:51], s34 offen sc1
    s_waitcnt vmcnt(0)
    v_pk_add_f32 v[64:65], v[64:65], v[68:69]
    v_pk_add_f32 v[66:67], v[66:67], v[70:71]
    v_mov_b64 v[56:57], v[64:65]
    v_mov_b64 v[58:59], v[66:67]
    s_nop 0
    v_permlane16_swap_b32 v64, v56
    v_permlane16_swap_b32 v65, v57
    v_permlane16_swap_b32 v66, v58
    v_permlane16_swap_b32 v67, v59
    v_pk_add_f32 v[64:65], v[64:65], v[56:57]
    v_pk_add_f32 v[66:67], v[66:67], v[58:59]
    v_mov_b64 v[56:57], v[64:65]
    v_mov_b64 v[58:59], v[66:67]
    s_nop 0
    v_permlane32_swap_b32 v64, v56
    v_permlane32_swap_b32 v65, v57
    v_permlane32_swap_b32 v66, v58
    v_permlane32_swap_b32 v67, v59
    v_pk_add_f32 v[64:65], v[64:65], v[56:57]
    v_pk_add_f32 v[66:67], v[66:67], v[58:59]
    v_pk_add_f32 v[42:43], v[64:65], v[66:67]
    v_cmp_u_f32 vcc, v42, v43
    s_add_u32 s58, s58, 1
    s_cmp_ge_u32 s58, 200000
    s_cbranch_scc1 L_D_go1
    s_sleep 2
    s_cbranch_vccnz L_D_poll1
L_D_go1:
    v_cvt_pk_bf16_f32 v42, v64, v65
    v_cvt_pk_bf16_f32 v43, v66, v67
    v_lshlrev_b32 v64, 16, v42
    v_and_b32 v65, 0xffff0000, v42
    v_lshlrev_b32 v66, 16, v43
    v_and_b32 v67, 0xffff0000, v43
    v_pk_add_f32 v[52:53], v[52:53], v[64:65]
    v_pk_add_f32 v[54:55], v[54:55], v[66:67]
    v_cvt_pk_bf16_f32 v42, v52, v53
    v_cvt_pk_bf16_f32 v43, v54, v55
    v_lshlrev_b32 v52, 16, v42
    v_and_b32 v53, 0xffff0000, v42
    v_lshlrev_b32 v54, 16, v43
    v_and_b32 v55, 0xffff0000, v43
    s_mov_b32 s58, 0
    s_mov_b32 s33, s35
    buffer_load_dwordx4 v[64:67], v47, s[48:51], s33 offen sc1
    s_add_u32 s33, s33, 32768
    buffer_load_dwordx4 v[68:71], v47, s[48:51], s33 offen sc1
    s_add_u32 s33, s33, 32768
    buffer_load_dwordx4 v[72:75], v47, s[48:51], s33 offen sc1
    s_add_u32 s33, s33, 32768
    buffer_load_dwordx4 v[76:79], v47, s[48:51], s33 offen sc1
    s_add_u32 s33, s33, 32768
    buffer_load_dwordx4 v[80:83], v47, s[48:51], s33 offen sc1
    s_add_u32 s33, s33, 32768
    buffer_load_dwordx4 v[84:87], v47, s[48:51], s33 offen sc1
    s_add_u32 s33, s33, 32768
    buffer_load_dwordx4 v[88:91], v47, s[48:51], s33 offen sc1
    s_add_u32 s33, s33, 32768
    buffer_load_dwordx4 v[92:95], v47, s[48:51], s33 offen sc1
    s_add_u32 s33, s33, 32768
    buffer_load_dwordx4 v[96:99], v47, s[48:51], s33 offen sc1
    s_add_u32 s33, s33, 32768
    buffer_load_dwordx4 v[100:103], v47, s[48:51], s33 offen sc1
    s_add_u32 s33, s33, 32768
    buffer_load_dwordx4 v[104:107], v47, s[48:51], s33 offen sc1
    s_add_u32 s33, s33, 32768
    buffer_load_dwordx4 v[108:111], v47, s[48:51], s33 offen sc1
    s_add_u32 s33, s33, 32768
    buffer_load_dwordx4 v[112:115], v47, s[48:51], s33 offen sc1
    s_add_u32 s33, s33, 32768
    buffer_load_dwordx4 v[116:119], v47, s[48:51], s33 offen sc1
    s_branch L_D_chk2
L_D_poll2:
    s_mov_b64 exec, s[72:73]
    s_mov_b32 s33, s35
    buffer_load_dwordx4 v[64:67], v47, s[48:51], s33 offen sc1
    s_add_u32 s33, s33, 32768
    buffer_load_dwordx4 v[68:71], v47, s[48:51], s33 offen sc1
    s_add_u32 s33, s33, 32768
    buffer_load_dwordx4 v[72:75], v47, s[48:51], s33 offen sc1
    s_add_u32 s33, s33, 32768
    buffer_load_dwordx4 v[76:79], v47, s[48:51], s33 offen sc1
    s_add_u32 s33, s33, 32768
    buffer_load_dwordx4 v[80:83], v47, s[48:51], s33 offen sc1
    s_add_u32 s33, s33, 32768
    buffer_load_dwordx4 v[84:87], v47, s[48:51], s33 offen sc1
    s_add_u32 s33, s33, 32768
    buffer_load_dwordx4 v[88:91], v47, s[48:51], s33 offen sc1
    s_add_u32 s33, s33, 32768
    buffer_load_dwordx4 v[92:95], v47, s[48:51], s33 offen sc1
    s_add_u32 s33, s33, 32768
    buffer_load_dwordx4 v[96:99], v47, s[48:51], s33 offen sc1
    s_add_u32 s33, s33, 32768
    buffer_load_dwordx4 v[100:103], v47, s[48:51], s33 offen sc1
    s_add_u32 s33, s33, 32768
    buffer_load_dwordx4 v[104:107], v47, s[48:51], s33 offen sc1
    s_add_u32 s33, s33, 32768
    buffer_load_dwordx4 v[108:111], v47, s[48:51], s33 offen sc1
    s_add_u32 s33, s33, 32768
    buffer_load_dwordx4 v[112:115], v47, s[48:51], s33 offen sc1
    s_add_u32 s33, s33, 32768
    buffer_load_dwordx4 v[116:119], v47, s[48:51], s33 offen sc1
    s_mov_b64 exec, -1
L_D_chk2:
    s_waitcnt vmcnt(0)
    v_pk_add_f32 v[60:61], v[64:65], v[68:69]
    v_pk_add_f32 v[62:63], v[66:67], v[70:71]
    v_pk_add_f32 v[60:61], v[60:61], v[72:73]
    v_pk_add_f32 v[62:63], v[62:63], v[74:75]
    v_pk_add_f32 v[60:61], v[60:61], v[76:77]
    v_pk_add_f32 v[62:63], v[62:63], v[78:79]
    v_pk_add_f32 v[60:61], v[60:61], v[80:81]
    v_pk_add_f32 v[62:63], v[62:63], v[82:83]
    v_pk_add_f32 v[60:61], v[60:61], v[84:85]
    v_pk_add_f32 v[62:63], v[62:63], v[86:87]
    v_pk_add_f32 v[60:61], v[60:61], v[88:89]
    v_pk_add_f32 v[62:63], v[62:63], v[90:91]
    v_pk_add_f32 v[60:61], v[60:61], v[92:93]
    v_pk_add_f32 v[62:63], v[62:63], v[94:95]
    v_pk_add_f32 v[60:61], v[60:61], v[96:97]
    v_pk_add_f32 v[62:63], v[62:63], v[98:99]
    v_pk_add_f32 v[60:61], v[60:61], v[100:101]
    v_pk_add_f32 v[62:63], v[62:63], v[102:103]
    v_pk_add_f32 v[60:61], v[60:61], v[104:105]
    v_pk_add_f32 v[62:63], v[62:63], v[106:107]
    v_pk_add_f32 v[60:61], v[60:61], v[108:109]
    v_pk_add_f32 v[62:63], v[62:63], v[110:111]
    v_pk_add_f32 v[60:61], v[60:61], v[112:113]
    v_pk_add_f32 v[62:63], v[62:63], v[114:115]
    v_pk_add_f32 v[60:61], v[60:61], v[116:117]
    v_pk_add_f32 v[62:63], v[62:63], v[118:119]
    v_pk_add_f32 v[42:43], v[60:61], v[62:63]
    v_cmp_u_f32 s[72:73], v42, v43
    s_add_u32 s58, s58, 1
    s_cmp_ge_u32 s58, 200000
    s_cbranch_scc1 L_D_go2
    s_cmp_lg_u64 s[72:73], 0
    s_cbranch_scc1 L_D_poll2
L_D_go2:
    v_mov_b64 v[56:57], v[60:61]
    v_mov_b64 v[58:59], v[62:63]
    s_nop 0
    v_permlane16_swap_b32 v60, v56
    v_permlane16_swap_b32 v61, v57
    v_permlane16_swap_b32 v62, v58
    v_permlane16_swap_b32 v63, v59
    v_pk_add_f32 v[60:61], v[60:61], v[56:57]
    v_pk_add_f32 v[62:63], v[62:63], v[58:59]
    v_mov_b64 v[56:57], v[60:61]
    v_mov_b64 v[58:59], v[62:63]
    s_nop 0
    v_permlane32_swap_b32 v60, v56
    v_permlane32_swap_b32 v61, v57
    v_permlane32_swap_b32 v62, v58
    v_permlane32_swap_b32 v63, v59
    v_pk_add_f32 v[60:61], v[60:61], v[56:57]
    v_pk_add_f32 v[62:63], v[62:63], v[58:59]
    v_cvt_pk_bf16_f32 v42, v60, v61
    v_cvt_pk_bf16_f32 v43, v62, v63
    v_lshlrev_b32 v60, 16, v42
    v_and_b32 v61, 0xffff0000, v42
    v_lshlrev_b32 v62, 16, v43
    v_and_b32 v63, 0xffff0000, v43
    v_pk_add_f32 v[52:53], v[52:53], v[60:61]
    v_pk_add_f32 v[54:55], v[54:55], v[62:63]
    v_cvt_pk_bf16_f32 v42, v52, v53
    v_cvt_pk_bf16_f32 v43, v54, v55
    s_mov_b32 exec_lo, 0xffff
    s_mov_b32 exec_hi, 0x0
    buffer_store_dwordx2 v[42:43], v46, s[64:67], 0 offen
    s_mov_b64 exec, -1
    s_cmp_lg_u32 s75, 120
    s_cbranch_scc1 L_D_noep
    s_add_u32 s62, s62, 1
    v_mov_b32 v40, s62
    v_mov_b32 v41, 1015808
    s_mov_b64 exec, 1
    buffer_store_dword v40, v41, s[48:51], 0 offen
    s_mov_b64 exec, -1
L_D_noep:
    s_endpgm
L_end:
    s_endpgm
L_code_end:
.section .rodata,"a"
.p2align 6
.amdhsa_kernel sequential_preLN__gqa_block_cached__swiglu_ffn__decode_kernel
  .amdhsa_next_free_vgpr 256
  .amdhsa_next_free_sgpr 100
  .amdhsa_accum_offset 256
  .amdhsa_group_segment_fixed_size 0
  .amdhsa_kernarg_size 96
  .amdhsa_user_sgpr_count 2
  .amdhsa_user_sgpr_kernarg_segment_ptr 1
  .amdhsa_system_sgpr_workgroup_id_x 1
.end_amdhsa_kernel
```
